```python
import torch

def _softmax(x, axis=-1):
    return torch.softmax(x, dim=axis)
def _gelu(x):
    return torch.nn.functional.gelu(x, approximate="tanh")
def _silu(x):
    return torch.nn.functional.silu(x)
def _sigmoid(x):
    return torch.sigmoid(x)
def _layernorm(x, axis=-1, eps=1e-5):
    m = x.mean(dim=axis, keepdim=True)
    v = x.var(dim=axis, keepdim=True, unbiased=False)
    return (x - m) / torch.sqrt(v + eps)
def _scatter_add(tgt, idx, src, axis=0):
    return tgt.clone().index_add_(axis, idx, src)
def _segment_sum(src, seg, n):
    out = torch.zeros((n,) + src.shape[1:], dtype=src.dtype)
    return out.index_add_(0, seg, src)
def _pad(x, pw):
    flat = tuple(v for pair in reversed(pw) for v in pair)
    return torch.nn.functional.pad(x, flat)

kernel_name = 'gated_mix__gqa_block_cached__moe_arch_mod__decode'

def setup_inputs():

    _w = (lambda a: (lambda t: t.to(torch.bfloat16) if t.is_floating_point() else t)(torch.as_tensor(a)))
    def _A_setup():
        B, Sq, D = 1, 1, 1024
        Hq, Hkv, Sk, Dh = 32, 4, 65536, 128
        assert Hq % Hkv == 0, (Hq, Hkv)
        return {
            "x": _w((lambda *s: torch.randn(*s, dtype=torch.bfloat16) * 0.05)(B, Sq, D)),
            "k_cache": _w((lambda *s: torch.randn(*s, dtype=torch.bfloat16) * 3.2)(B, Hkv, Sk, Dh)),
            "v_cache": _w((lambda *s: torch.randn(*s, dtype=torch.bfloat16) * 1.6)(B, Hkv, Sk, Dh)),
            "wq": _w((lambda *s: torch.randn(*s, dtype=torch.bfloat16) * 3.2)(D, Hq * Dh) * (D ** -0.5)),
            "wo": _w((lambda *s: torch.randn(*s, dtype=torch.bfloat16) * 1.6)(Hq * Dh, D) * ((Hq * Dh) ** -0.5)),
        }
    _A_in = _A_setup()

    def _B_setup():
        B, S, D, F, C = 1, 1, 1024, 3584, 1
        return {
            "x": _w((lambda *s: torch.randn(*s, dtype=torch.bfloat16) * 0.05)(B, S, D)),
            "w_r": _w((lambda *s: torch.randn(*s, dtype=torch.bfloat16) * 0.05)(D)),
            "w_gate": _w((lambda *s: torch.randn(*s, dtype=torch.bfloat16) * 0.05)(D, F)),
            "w_up": _w((lambda *s: torch.randn(*s, dtype=torch.bfloat16) * 0.05)(D, F)),
            "w_down": _w((lambda *s: torch.randn(*s, dtype=torch.bfloat16) * 0.05)(F, D)),
        }
    _B_in = _B_setup()

    return {
        "A_x": _A_in["x"],
        "A_k_cache": _A_in["k_cache"],
        "A_v_cache": _A_in["v_cache"],
        "A_wq": _A_in["wq"],
        "A_wo": _A_in["wo"],
        "B_x": _B_in["x"],
        "B_w_r": _B_in["w_r"],
        "B_w_gate": _B_in["w_gate"],
        "B_w_up": _B_in["w_up"],
        "B_w_down": _B_in["w_down"],
        "gate_w": _w((lambda *s: torch.randn(*s, dtype=torch.bfloat16) * 0.05)(1024) * 16.0),
    }

def reference(A_x, A_k_cache, A_v_cache, A_wq, A_wo, B_x, B_w_r, B_w_gate, B_w_up, B_w_down, gate_w):
    def _A_ref(x, k_cache, v_cache, wq, wo):
        B, Sq, D = x.shape
        Hq, Dh = 32, 128
        Hkv = k_cache.shape[1]
        rep = Hq // Hkv
        q = (lambda x, *d: x.permute(*d))((x @ wq).reshape(B, Sq, Hq, Dh), 0, 2, 1, 3)
        k = (lambda x, n, axis: torch.repeat_interleave(x, n, dim=axis))(k_cache, rep, axis=1)
        v = (lambda x, n, axis: torch.repeat_interleave(x, n, dim=axis))(v_cache, rep, axis=1)
        scores = torch.einsum("bhqd,bhkd->bhqk", q, k) * (Dh ** -0.5)
        p = _softmax(scores, axis=-1)
        o = torch.einsum("bhqk,bhkd->bhqd", p, v)
        return (lambda x, *d: x.permute(*d))(o, 0, 2, 1, 3).reshape(B, Sq, Hq * Dh) @ wo

    def _B_ref(x, w_r, w_gate, w_up, w_down):
        B, S, D = x.shape
        C = 1
        r = x @ w_r
        idx = torch.argsort(-r, axis=-1)[:, :C]
        idx_e = (lambda x, n, axis: torch.repeat_interleave(x, n, dim=axis))(idx.reshape(B, C, 1), D, axis=2)
        x_sel = (lambda x, i, axis: torch.take_along_dim(x, i, dim=axis))(x, idx_e, axis=1)
        g = _silu(x_sel @ w_gate)
        u = x_sel @ w_up
        y = (g * u) @ w_down
        r_sel = _sigmoid((lambda x, i, axis: torch.take_along_dim(x, i, dim=axis))(r, idx, axis=1))
        y = y * r_sel.reshape(B, C, 1)
        b_off = (torch.arange(B) * S).reshape(B, 1)
        flat_idx = (idx + b_off).reshape(B * C)
        zero = (x * 0.0).reshape(B * S, D)
        upd = _scatter_add(zero, flat_idx, y.reshape(B * C, D), axis=0)
        return x + upd.reshape(B, S, D)

    x = A_x
    g = _sigmoid((x * gate_w).sum(-1, keepdims=True))
    a = _A_ref(x, A_k_cache, A_v_cache, A_wq, A_wo)
    b = _B_ref(x, B_w_r, B_w_gate, B_w_up, B_w_down)
    return g * a + (1 - g) * b
```

```asm
; @launch grid=(256,1,1) block=(512,1,1) lds=48128
.amdgcn_target "amdgcn-amd-amdhsa--gfx950"
.text
.globl gated_mix__gqa_block_cached__moe_arch_mod__decode_kernel
.p2align 8
.type gated_mix__gqa_block_cached__moe_arch_mod__decode_kernel,@function
gated_mix__gqa_block_cached__moe_arch_mod__decode_kernel:
    s_cmp_ge_u32 s2, 256
    s_cbranch_scc1 L_END
    s_mov_b32 s97, s2
    s_xor_b32 s2, s2, 0
    s_load_dwordx2 s[16:17], s[0:1], 0
    s_load_dwordx2 s[20:21], s[0:1], 24
    s_load_dwordx2 s[28:29], s[0:1], 96
    s_load_dwordx2 s[24:25], s[0:1], 56
    s_load_dwordx2 s[68:69], s[0:1], 64
    s_load_dwordx2 s[4:5], s[0:1], 8
    s_load_dwordx2 s[8:9], s[0:1], 16
    s_load_dwordx2 s[12:13], s[0:1], 104
    s_load_dwordx2 s[84:85], s[0:1], 32
    s_load_dwordx2 s[88:89], s[0:1], 72
    s_load_dwordx2 s[32:33], s[0:1], 88
    s_load_dwordx2 s[36:37], s[0:1], 48
    s_load_dwordx2 s[40:41], s[0:1], 80
    s_memrealtime s[70:71]
    v_and_b32 v1, 63, v0
    v_lshrrev_b32 v2, 6, v0
    v_lshrrev_b32 v3, 4, v1
    v_and_b32 v4, 15, v1
    v_mov_b32 v0, 0
    v_readfirstlane_b32 s3, v2
    s_lshr_b32 s44, s2, 6
    s_and_b32 s45, s2, 63
    v_bfe_u32 v5, v1, 2, 2
    v_lshlrev_b32 v5, 10, v5
    v_bfe_u32 v8, v1, 1, 1
    v_lshl_add_u32 v5, v8, 8, v5
    v_lshl_add_u32 v5, v3, 5, v5
    v_and_b32 v8, 1, v1
    v_lshl_add_u32 v5, v8, 4, v5
    v_lshlrev_b32 v6, 10, v3
    v_lshl_add_u32 v6, v4, 4, v6
    s_lshl_b32 s48, s2, 18
    s_lshl_b32 s64, s3, 12
    s_add_u32 s48, s48, s64
    s_add_u32 s49, s48, 32768
    s_add_u32 s50, s48, 65536
    s_add_u32 s51, s48, 98304
    s_add_u32 s52, s48, 131072
    s_add_u32 s53, s48, 163840
    s_add_u32 s54, s48, 196608
    s_add_u32 s55, s48, 229376
    v_lshrrev_b32 v56, 3, v1
    v_and_b32 v58, 7, v1
    v_lshlrev_b32 v10, 15, v56
    v_lshl_add_u32 v10, v58, 4, v10
    v_lshlrev_b32 v11, 3, v56
    v_mul_u32_u24 v60, 28672, v56
    v_lshl_add_u32 v60, v58, 4, v60
    s_bfe_u32 s76, s2, 0x30003
    s_bfe_u32 s64, s2, 0x10002
    s_lshl_b32 s64, s64, 3
    s_add_u32 s64, s64, s76
    s_and_b32 s65, s45, 3
    s_lshl_b32 s66, s65, 8
    s_lshl_b32 s67, s3, 5
    s_add_u32 s66, s66, s67
    s_lshl_b32 s57, s66, 1
    s_lshl_b32 s56, s66, 13
    s_lshl_b32 s67, s44, 11
    s_add_u32 s56, s56, s67
    s_lshl_b32 s67, s64, 7
    s_add_u32 s56, s56, s67
    s_lshl_b32 s82, s44, 14
    s_lshr_b32 s67, s64, 1
    s_lshl_b32 s67, s67, 11
    s_add_u32 s92, s82, s67
    s_lshl_b32 s67, s65, 9
    s_add_u32 s92, s92, s67
    s_and_b32 s67, s64, 1
    s_lshl_b32 s67, s67, 8
    s_add_u32 s92, s92, s67
    s_lshl_b32 s67, s3, 11
    s_add_u32 s82, s82, s67
    v_and_b32 v9, 1, v3
    v_lshlrev_b32 v9, 1, v9
    v_lshrrev_b32 v8, 1, v3
    v_or_b32 v9, v9, v8
    v_bfe_u32 v8, v1, 3, 1
    v_lshl_add_u32 v9, v8, 2, v9
    v_lshl_add_u32 v9, v58, 3, v9
    v_lshlrev_b32 v9, 2, v9
    v_lshl_add_u32 v7, v2, 8, v9
    s_cmp_gt_u32 s76, 3
    s_cselect_b32 s65, 1, 0
    s_sub_u32 s65, s76, s65
    s_lshl_b32 s65, s65, 3
    s_mul_i32 s98, s44, 56
    s_add_u32 s98, s98, s65
    s_and_b32 s65, s2, 7
    s_add_u32 s98, s98, s65
    s_lshl_b32 s66, s44, 3
    s_add_u32 s66, s66, s65
    s_sub_u32 s67, s98, 196
    s_cmp_ge_u32 s98, 196
    s_cselect_b32 s99, 1, 0
    s_add_u32 s65, s66, 28
    s_cmp_eq_u32 s76, 3
    s_cselect_b32 s67, s65, s67
    s_cselect_b32 s99, 1, s99
    s_cselect_b32 s98, s66, s98
    s_cmp_lg_u32 s99, 0
    s_cbranch_scc1 L_GQ
    s_lshr_b32 s64, s98, 2
    s_mul_i32 s65, s64, 37
    s_lshr_b32 s65, s65, 8
    s_mul_i32 s66, s65, 7
    s_sub_u32 s64, s64, s66
    s_cmp_ge_u32 s64, 3
    s_addc_u32 s64, s64, 0
    s_lshl_b32 s65, s65, 3
    s_add_u32 s64, s64, s65
    s_bfe_u32 s100, s98, 0x10001
    s_and_b32 s66, s98, 1
    s_lshl_b32 s65, s66, 9
    s_lshl_b32 s67, s3, 6
    s_add_u32 s65, s65, s67
    s_mov_b32 s67, 0
    s_branch L_GC
    L_GQ:
    s_min_u32 s66, s67, 55
    s_lshr_b32 s64, s66, 3
    s_lshl_b32 s64, s64, 3
    s_add_u32 s64, s64, 3
    s_bfe_u32 s100, s66, 0x10002
    s_and_b32 s66, s66, 3
    s_lshl_b32 s65, s66, 8
    s_lshl_b32 s101, s3, 5
    s_add_u32 s65, s65, s101
    L_GC:
    s_lshl_b32 s59, s65, 1
    s_mul_i32 s58, s65, 7168
    s_lshl_b32 s65, s64, 7
    s_add_u32 s58, s58, s65
    s_lshl_b32 s93, s64, 11
    s_lshl_b32 s65, s100, 10
    s_add_u32 s93, s93, s65
    s_lshl_b32 s65, s66, 8
    s_add_u32 s93, s93, s65
    s_lshl_b32 s65, s67, 8
    s_add_u32 s65, s65, 100352
    s_cmp_ge_u32 s67, 56
    s_cselect_b32 s93, s65, s93
    s_add_u32 s93, s93, 131072
    s_mov_b32 s80, s100
    s_and_b32 s64, s98, 0xf8
    s_add_u32 s64, s64, s3
    s_lshl_b32 s62, s64, 15
    s_and_b32 s65, s98, 7
    s_lshl_b32 s65, s65, 8
    s_add_u32 s62, s62, s65
    s_add_u32 s63, s62, 4096
    s_lshr_b32 s65, s64, 2
    s_lshl_b32 s83, s65, 11
    s_and_b32 s65, s65, 7
    s_cmp_eq_u32 s65, 3
    s_cselect_b32 s100, 1.0, 0.5
    s_cselect_b32 s101, 3, 1
    s_and_b32 s65, s64, 3
    s_lshl_b32 s65, s65, 6
    s_add_u32 s83, s83, s65
    s_add_u32 s83, s83, 131072
    s_lshl_b32 s60, s2, 15
    s_lshl_b32 s65, s3, 8
    s_add_u32 s60, s60, s65
    s_add_u32 s61, s60, 4096
    s_mov_b32 s77, 0xffffff00
    s_mov_b32 s72, 0x05040100
    s_mov_b32 s73, 0x07060302
    s_mov_b32 s81, 0x3f803f80
    s_mov_b32 s46, 0
    s_mov_b32 s47, 0
    s_mov_b32 s96, 0
    s_waitcnt lgkmcnt(0)
    s_and_b32 s64, s97, 7
    s_lshr_b32 s65, 0, s64
    s_and_b32 s65, s65, 1
    s_lshr_b32 s64, 0, s64
    s_and_b32 s64, s64, 1
    s_add_u32 s0, s65, 1
    s_sub_u32 s0, s0, s64
    s_mov_b32 s1, 4
    s_cmp_eq_u32 s80, 0
    s_cbranch_scc1 L_GSEL
    s_mov_b64 s[24:25], s[68:69]
L_GSEL:
    s_and_b32 s17, s17, 0xffff
    s_mov_b32 s18, 2048
    s_mov_b32 s19, 0x00020000
    s_and_b32 s21, s21, 0xffff
    s_mov_b32 s22, 8388608
    s_mov_b32 s23, 0x00020000
    s_and_b32 s29, s29, 0xffff
    s_mov_b32 s30, 256
    s_mov_b32 s31, 0x00020000
    s_and_b32 s25, s25, 0xffff
    s_mov_b32 s26, 7340032
    s_mov_b32 s27, 0x00020000
    s_and_b32 s5, s5, 0xffff
    s_mov_b32 s6, 67108864
    s_mov_b32 s7, 0x00020000
    s_and_b32 s9, s9, 0xffff
    s_mov_b32 s10, 67108864
    s_mov_b32 s11, 0x00020000
    s_and_b32 s13, s13, 0xffff
    s_mov_b32 s14, 268435456
    s_mov_b32 s15, 0x00020000
    s_and_b32 s85, s85, 0xffff
    s_mov_b32 s86, 8388608
    s_mov_b32 s87, 0x00020000
    s_and_b32 s89, s89, 0xffff
    s_mov_b32 s90, 7340032
    s_mov_b32 s91, 0x00020000
    s_and_b32 s33, s33, 0xffff
    s_mov_b32 s34, 2048
    s_mov_b32 s35, 0x00020000
    s_and_b32 s37, s37, 0xffff
    s_mov_b32 s38, 2048
    s_mov_b32 s39, 0x00020000
    s_and_b32 s41, s41, 0xffff
    s_mov_b32 s42, 2048
    s_mov_b32 s43, 0x00020000
    s_cmp_lg_u32 s3, 0
    s_cbranch_scc1 L_NOT0
    s_cmp_eq_u32 s2, 0
    s_cbranch_scc0 L_W0_T1
    s_or_b32 s96, s70, 1
    v_mov_b32 v58, s96
    v_mov_b32 v59, 0
    s_mov_b64 exec, 1
    buffer_atomic_cmpswap v[58:59], off, s[28:31], 0 sc0 sc1
    s_mov_b64 exec, -1
    s_branch L_W0_T2
L_W0_T1:
    buffer_load_dword v58, off, s[28:31], 0 sc1
L_W0_T2:
    v_mov_b32 v56, 0
    v_lshlrev_b32 v57, 2, v1
    ds_write_b32 v57, v56 offset:10880
L_NOT0:
    buffer_load_dwordx2 v[8:9], v11, s[16:19], s57 offen
    buffer_load_dwordx4 v[16:19], v10, s[20:23], s56 offen nt
    s_add_u32 s56, s56, 8192
    buffer_load_dwordx4 v[20:23], v10, s[20:23], s56 offen nt
    s_add_u32 s56, s56, 8192
    buffer_load_dwordx4 v[24:27], v10, s[20:23], s56 offen nt
    s_add_u32 s56, s56, 8192
    buffer_load_dwordx4 v[28:31], v10, s[20:23], s56 offen nt
    s_cmp_eq_u32 s76, 3
    s_cbranch_scc1 L_LIGHT
    buffer_load_dwordx2 v[96:97], v11, s[16:19], s59 offen
    buffer_load_dwordx4 v[64:67], v60, s[24:27], s58 offen nt
    s_add_u32 s58, s58, 7168
    buffer_load_dwordx4 v[68:71], v60, s[24:27], s58 offen nt
    s_add_u32 s58, s58, 7168
    s_waitcnt lgkmcnt(0)
    s_barrier
    s_waitcnt vmcnt(3)
    v_mov_b32 v48, 0
    v_mov_b32 v49, 0
    v_mov_b32 v50, 0
    v_mov_b32 v51, 0
    v_mov_b32 v52, 0
    v_mov_b32 v53, 0
    v_mov_b32 v54, 0
    v_mov_b32 v55, 0
    v_and_b32 v56, 0xffff, v8
    v_lshlrev_b32 v59, 16, v8
    v_dot2c_f32_bf16 v48, v16, v56
    v_dot2c_f32_bf16 v49, v16, v59
    v_dot2c_f32_bf16 v50, v17, v56
    v_dot2c_f32_bf16 v51, v17, v59
    v_dot2c_f32_bf16 v52, v18, v56
    v_dot2c_f32_bf16 v53, v18, v59
    v_dot2c_f32_bf16 v54, v19, v56
    v_dot2c_f32_bf16 v55, v19, v59
    v_lshrrev_b32 v56, 16, v8
    v_and_b32 v59, 0xffff0000, v8
    v_dot2c_f32_bf16 v48, v20, v56
    v_dot2c_f32_bf16 v49, v20, v59
    v_dot2c_f32_bf16 v50, v21, v56
    v_dot2c_f32_bf16 v51, v21, v59
    v_dot2c_f32_bf16 v52, v22, v56
    v_dot2c_f32_bf16 v53, v22, v59
    v_dot2c_f32_bf16 v54, v23, v56
    v_dot2c_f32_bf16 v55, v23, v59
    s_waitcnt vmcnt(2)
    buffer_load_dwordx4 v[72:75], v60, s[24:27], s58 offen nt
    s_add_u32 s58, s58, 7168
    v_and_b32 v56, 0xffff, v9
    v_lshlrev_b32 v59, 16, v9
    v_dot2c_f32_bf16 v48, v24, v56
    v_dot2c_f32_bf16 v49, v24, v59
    v_dot2c_f32_bf16 v50, v25, v56
    v_dot2c_f32_bf16 v51, v25, v59
    v_dot2c_f32_bf16 v52, v26, v56
    v_dot2c_f32_bf16 v53, v26, v59
    v_dot2c_f32_bf16 v54, v27, v56
    v_dot2c_f32_bf16 v55, v27, v59
    v_lshrrev_b32 v56, 16, v9
    v_and_b32 v59, 0xffff0000, v9
    v_dot2c_f32_bf16 v48, v28, v56
    v_dot2c_f32_bf16 v49, v28, v59
    v_dot2c_f32_bf16 v50, v29, v56
    v_dot2c_f32_bf16 v51, v29, v59
    v_dot2c_f32_bf16 v52, v30, v56
    v_dot2c_f32_bf16 v53, v30, v59
    v_dot2c_f32_bf16 v54, v31, v56
    v_dot2c_f32_bf16 v55, v31, v59
    s_waitcnt vmcnt(2)
    buffer_load_dwordx4 v[76:79], v60, s[24:27], s58 offen nt
    s_nop 1
    v_permlane32_swap_b32 v48, v49
    v_permlane32_swap_b32 v50, v51
    v_permlane32_swap_b32 v52, v53
    v_permlane32_swap_b32 v54, v55
    v_add_f32 v48, v48, v49
    v_add_f32 v50, v50, v51
    v_add_f32 v52, v52, v53
    v_add_f32 v54, v54, v55
    s_nop 1
    v_permlane16_swap_b32 v48, v50
    v_permlane16_swap_b32 v52, v54
    v_add_f32 v48, v48, v50
    v_add_f32 v52, v52, v54
    s_nop 1
    v_add_f32_dpp v48, v48, v48 row_ror:8 row_mask:0xf bank_mask:0xf
    v_add_f32_dpp v52, v52, v52 row_ror:8 row_mask:0xf bank_mask:0xf
    v_and_b32 v56, 8, v1
    v_cmp_ne_u32 vcc, 0, v56
    s_nop 1
    v_cndmask_b32 v48, v48, v52, vcc
    ds_write_b32 v7, v48 offset:0
    v_mov_b32 v56, 0
    v_mov_b32 v59, 1
    s_waitcnt lgkmcnt(0)
    s_mov_b64 exec, 1
    ds_add_u32 v56, v59 offset:10960
    s_mov_b64 exec, -1
    s_waitcnt vmcnt(2)
    s_cmp_lg_u32 s99, 0
    s_cbranch_scc1 L_G21
    s_add_u32 s58, s58, 207872
    buffer_load_dwordx2 v[98:99], v11, s[16:19], s59 offen offset:64
    buffer_load_dwordx4 v[80:83], v60, s[24:27], s58 offen nt
    s_add_u32 s58, s58, 7168
    s_waitcnt vmcnt(2)
    buffer_load_dwordx4 v[84:87], v60, s[24:27], s58 offen nt
    s_add_u32 s58, s58, 7168
    s_waitcnt vmcnt(2)
    buffer_load_dwordx4 v[88:91], v60, s[24:27], s58 offen nt
    s_add_u32 s58, s58, 7168
    s_waitcnt vmcnt(2)
    buffer_load_dwordx4 v[92:95], v60, s[24:27], s58 offen nt
L_G21:
    s_waitcnt vmcnt(2)
    buffer_load_dwordx4 v[128:131], v5, s[4:7], s48 offen offset:0 nt
    s_waitcnt vmcnt(2)
    buffer_load_dwordx4 v[132:135], v5, s[4:7], s48 offen offset:128 nt
    s_waitcnt vmcnt(2)
    buffer_load_dwordx4 v[136:139], v5, s[4:7], s48 offen offset:512 nt
    s_waitcnt vmcnt(3)
    v_mov_b32 v48, 0
    v_mov_b32 v49, 0
    v_mov_b32 v50, 0
    v_mov_b32 v51, 0
    v_mov_b32 v52, 0
    v_mov_b32 v53, 0
    v_mov_b32 v54, 0
    v_mov_b32 v55, 0
    v_and_b32 v56, 0xffff, v96
    v_lshlrev_b32 v59, 16, v96
    v_dot2c_f32_bf16 v48, v64, v56
    v_dot2c_f32_bf16 v49, v64, v59
    v_dot2c_f32_bf16 v50, v65, v56
    v_dot2c_f32_bf16 v51, v65, v59
    v_dot2c_f32_bf16 v52, v66, v56
    v_dot2c_f32_bf16 v53, v66, v59
    v_dot2c_f32_bf16 v54, v67, v56
    v_dot2c_f32_bf16 v55, v67, v59
    v_lshrrev_b32 v56, 16, v96
    v_and_b32 v59, 0xffff0000, v96
    v_dot2c_f32_bf16 v48, v68, v56
    v_dot2c_f32_bf16 v49, v68, v59
    v_dot2c_f32_bf16 v50, v69, v56
    v_dot2c_f32_bf16 v51, v69, v59
    v_dot2c_f32_bf16 v52, v70, v56
    v_dot2c_f32_bf16 v53, v70, v59
    v_dot2c_f32_bf16 v54, v71, v56
    v_dot2c_f32_bf16 v55, v71, v59
    s_waitcnt vmcnt(2)
    buffer_load_dwordx4 v[140:143], v5, s[4:7], s48 offen offset:640 nt
    v_and_b32 v56, 0xffff, v97
    v_lshlrev_b32 v59, 16, v97
    v_dot2c_f32_bf16 v48, v72, v56
    v_dot2c_f32_bf16 v49, v72, v59
    v_dot2c_f32_bf16 v50, v73, v56
    v_dot2c_f32_bf16 v51, v73, v59
    v_dot2c_f32_bf16 v52, v74, v56
    v_dot2c_f32_bf16 v53, v74, v59
    v_dot2c_f32_bf16 v54, v75, v56
    v_dot2c_f32_bf16 v55, v75, v59
    v_lshrrev_b32 v56, 16, v97
    v_and_b32 v59, 0xffff0000, v97
    v_dot2c_f32_bf16 v48, v76, v56
    v_dot2c_f32_bf16 v49, v76, v59
    v_dot2c_f32_bf16 v50, v77, v56
    v_dot2c_f32_bf16 v51, v77, v59
    v_dot2c_f32_bf16 v52, v78, v56
    v_dot2c_f32_bf16 v53, v78, v59
    v_dot2c_f32_bf16 v54, v79, v56
    v_dot2c_f32_bf16 v55, v79, v59
    s_waitcnt vmcnt(2)
    buffer_load_dwordx4 v[144:147], v5, s[4:7], s49 offen offset:0 nt
    s_cmp_lg_u32 s99, 0
    s_cbranch_scc1 L_GS2
    v_and_b32 v56, 0xffff, v98
    v_lshlrev_b32 v59, 16, v98
    v_dot2c_f32_bf16 v48, v80, v56
    v_dot2c_f32_bf16 v49, v80, v59
    v_dot2c_f32_bf16 v50, v81, v56
    v_dot2c_f32_bf16 v51, v81, v59
    v_dot2c_f32_bf16 v52, v82, v56
    v_dot2c_f32_bf16 v53, v82, v59
    v_dot2c_f32_bf16 v54, v83, v56
    v_dot2c_f32_bf16 v55, v83, v59
    v_lshrrev_b32 v56, 16, v98
    v_and_b32 v59, 0xffff0000, v98
    v_dot2c_f32_bf16 v48, v84, v56
    v_dot2c_f32_bf16 v49, v84, v59
    v_dot2c_f32_bf16 v50, v85, v56
    v_dot2c_f32_bf16 v51, v85, v59
    v_dot2c_f32_bf16 v52, v86, v56
    v_dot2c_f32_bf16 v53, v86, v59
    v_dot2c_f32_bf16 v54, v87, v56
    v_dot2c_f32_bf16 v55, v87, v59
L_GS2:
    s_waitcnt vmcnt(2)
    buffer_load_dwordx4 v[148:151], v5, s[4:7], s49 offen offset:128 nt
    s_cmp_lg_u32 s99, 0
    s_cbranch_scc1 L_GS3
    v_and_b32 v56, 0xffff, v99
    v_lshlrev_b32 v59, 16, v99
    v_dot2c_f32_bf16 v48, v88, v56
    v_dot2c_f32_bf16 v49, v88, v59
    v_dot2c_f32_bf16 v50, v89, v56
    v_dot2c_f32_bf16 v51, v89, v59
    v_dot2c_f32_bf16 v52, v90, v56
    v_dot2c_f32_bf16 v53, v90, v59
    v_dot2c_f32_bf16 v54, v91, v56
    v_dot2c_f32_bf16 v55, v91, v59
    v_lshrrev_b32 v56, 16, v99
    v_and_b32 v59, 0xffff0000, v99
    v_dot2c_f32_bf16 v48, v92, v56
    v_dot2c_f32_bf16 v49, v92, v59
    v_dot2c_f32_bf16 v50, v93, v56
    v_dot2c_f32_bf16 v51, v93, v59
    v_dot2c_f32_bf16 v52, v94, v56
    v_dot2c_f32_bf16 v53, v94, v59
    v_dot2c_f32_bf16 v54, v95, v56
    v_dot2c_f32_bf16 v55, v95, v59
L_GS3:
    s_waitcnt vmcnt(2)
    buffer_load_dwordx4 v[152:155], v5, s[4:7], s49 offen offset:512 nt
    s_nop 1
    v_permlane32_swap_b32 v48, v49
    v_permlane32_swap_b32 v50, v51
    v_permlane32_swap_b32 v52, v53
    v_permlane32_swap_b32 v54, v55
    v_add_f32 v48, v48, v49
    v_add_f32 v50, v50, v51
    v_add_f32 v52, v52, v53
    v_add_f32 v54, v54, v55
    s_nop 1
    v_permlane16_swap_b32 v48, v50
    v_permlane16_swap_b32 v52, v54
    v_add_f32 v48, v48, v50
    v_add_f32 v52, v52, v54
    s_nop 1
    v_add_f32_dpp v48, v48, v48 row_ror:8 row_mask:0xf bank_mask:0xf
    v_add_f32_dpp v52, v52, v52 row_ror:8 row_mask:0xf bank_mask:0xf
    v_and_b32 v56, 8, v1
    v_cmp_ne_u32 vcc, 0, v56
    s_nop 1
    v_cndmask_b32 v48, v48, v52, vcc
    ds_write_b32 v7, v48 offset:2048
    v_mov_b32 v56, 0
    v_mov_b32 v59, 1
    s_waitcnt lgkmcnt(0)
    s_mov_b64 exec, 1
    ds_add_u32 v56, v59 offset:10964
    s_mov_b64 exec, -1
    s_waitcnt vmcnt(2)
    buffer_load_dwordx4 v[156:159], v5, s[4:7], s49 offen offset:640 nt
    s_cmp_lg_u32 s3, 0
    s_cbranch_scc1 L_HS4
    s_cmp_lg_u32 s46, 0
    s_cbranch_scc1 L_HS4
    s_mov_b32 s76, 0
    s_cmp_lg_u32 s47, 0
    s_cbranch_scc1 L_HH5
    s_waitcnt vmcnt(18)
L_HR6:
    v_readfirstlane_b32 s47, v58
    s_cmp_eq_u32 s47, 0
    s_cselect_b32 s47, s96, s47
    s_cmp_lg_u32 s47, 0
    s_cbranch_scc1 L_HG7
    buffer_load_dword v58, off, s[28:31], 0 sc1
    s_branch L_HS4
L_HG7:
    v_mov_b32 v56, 0
    v_mov_b32 v59, s47
    ds_write_b32 v56, v59 offset:10968
L_HH5:
    v_mov_b32 v56, 0
L_HQ8:
    ds_read_b64 v[96:97], v56 offset:10960
    s_waitcnt lgkmcnt(0)
    v_readfirstlane_b32 s64, v96
    v_readfirstlane_b32 s65, v97
    s_add_u32 s64, s64, s65
    s_cmp_eq_u32 s64, 16
    s_cbranch_scc0 L_HS4
    v_and_b32 v56, 1, v3
    v_lshlrev_b32 v59, 11, v56
    v_lshl_add_u32 v59, v4, 4, v59
    ds_read_b128 v[64:67], v59 offset:0
    ds_read_b128 v[68:71], v59 offset:256
    ds_read_b128 v[72:75], v59 offset:512
    ds_read_b128 v[76:79], v59 offset:768
    ds_read_b128 v[80:83], v59 offset:1024
    ds_read_b128 v[84:87], v59 offset:1280
    ds_read_b128 v[88:91], v59 offset:1536
    ds_read_b128 v[92:95], v59 offset:1792
    v_mov_b32 v15, s47
    v_and_b32 v12, 0xff, v15
    v_bfe_u32 v13, v15, 8, 8
    v_bfe_u32 v14, v15, 16, 8
    v_lshrrev_b32 v15, 24, v15
    v_mov_b32 v59, s92
    v_mov_b32 v96, s93
    v_cmp_ne_u32 vcc, 0, v56
    s_nop 1
    v_cndmask_b32 v59, v59, v96, vcc
    v_lshl_add_u32 v59, v4, 4, v59
    s_waitcnt lgkmcnt(0)
    v_pk_add_f32 v[64:65], v[64:65], v[68:69]
    v_pk_add_f32 v[66:67], v[66:67], v[70:71]
    v_pk_add_f32 v[72:73], v[72:73], v[76:77]
    v_pk_add_f32 v[74:75], v[74:75], v[78:79]
    v_pk_add_f32 v[80:81], v[80:81], v[84:85]
    v_pk_add_f32 v[82:83], v[82:83], v[86:87]
    v_pk_add_f32 v[88:89], v[88:89], v[92:93]
    v_pk_add_f32 v[90:91], v[90:91], v[94:95]
    v_pk_add_f32 v[64:65], v[64:65], v[72:73]
    v_pk_add_f32 v[66:67], v[66:67], v[74:75]
    v_pk_add_f32 v[80:81], v[80:81], v[88:89]
    v_pk_add_f32 v[82:83], v[82:83], v[90:91]
    v_pk_add_f32 v[64:65], v[64:65], v[80:81]
    v_pk_add_f32 v[66:67], v[66:67], v[82:83]
    v_bfi_b32 v64, s77, v64, v12
    v_bfi_b32 v65, s77, v65, v13
    v_bfi_b32 v66, s77, v66, v14
    v_bfi_b32 v67, s77, v67, v15
    s_mov_b64 exec, 0xffffffff
    buffer_store_dwordx4 v[64:67], v59, s[12:15], 0 offen sc1
    s_mov_b64 exec, -1
    s_mov_b32 s46, 1
L_HS4:
    s_waitcnt vmcnt(2)
    buffer_load_dwordx4 v[160:163], v5, s[4:7], s50 offen offset:0 nt
    s_waitcnt vmcnt(2)
    buffer_load_dwordx4 v[164:167], v5, s[4:7], s50 offen offset:128 nt
    s_cmp_lg_u32 s3, 0
    s_cbranch_scc1 L_HS9
    s_cmp_lg_u32 s46, 0
    s_cbranch_scc1 L_HS9
    s_mov_b32 s76, 0
    s_cmp_lg_u32 s47, 0
    s_cbranch_scc1 L_HH10
    s_waitcnt vmcnt(2)
L_HR11:
    v_readfirstlane_b32 s47, v58
    s_cmp_eq_u32 s47, 0
    s_cselect_b32 s47, s96, s47
    s_cmp_lg_u32 s47, 0
    s_cbranch_scc1 L_HG12
    buffer_load_dword v58, off, s[28:31], 0 sc1
    s_branch L_HS9
L_HG12:
    v_mov_b32 v56, 0
    v_mov_b32 v59, s47
    ds_write_b32 v56, v59 offset:10968
L_HH10:
    v_mov_b32 v56, 0
L_HQ13:
    ds_read_b64 v[96:97], v56 offset:10960
    s_waitcnt lgkmcnt(0)
    v_readfirstlane_b32 s64, v96
    v_readfirstlane_b32 s65, v97
    s_add_u32 s64, s64, s65
    s_cmp_eq_u32 s64, 16
    s_cbranch_scc0 L_HS9
    v_and_b32 v56, 1, v3
    v_lshlrev_b32 v59, 11, v56
    v_lshl_add_u32 v59, v4, 4, v59
    ds_read_b128 v[64:67], v59 offset:0
    ds_read_b128 v[68:71], v59 offset:256
    ds_read_b128 v[72:75], v59 offset:512
    ds_read_b128 v[76:79], v59 offset:768
    ds_read_b128 v[80:83], v59 offset:1024
    ds_read_b128 v[84:87], v59 offset:1280
    ds_read_b128 v[88:91], v59 offset:1536
    ds_read_b128 v[92:95], v59 offset:1792
    v_mov_b32 v15, s47
    v_and_b32 v12, 0xff, v15
    v_bfe_u32 v13, v15, 8, 8
    v_bfe_u32 v14, v15, 16, 8
    v_lshrrev_b32 v15, 24, v15
    v_mov_b32 v59, s92
    v_mov_b32 v96, s93
    v_cmp_ne_u32 vcc, 0, v56
    s_nop 1
    v_cndmask_b32 v59, v59, v96, vcc
    v_lshl_add_u32 v59, v4, 4, v59
    s_waitcnt lgkmcnt(0)
    v_pk_add_f32 v[64:65], v[64:65], v[68:69]
    v_pk_add_f32 v[66:67], v[66:67], v[70:71]
    v_pk_add_f32 v[72:73], v[72:73], v[76:77]
    v_pk_add_f32 v[74:75], v[74:75], v[78:79]
    v_pk_add_f32 v[80:81], v[80:81], v[84:85]
    v_pk_add_f32 v[82:83], v[82:83], v[86:87]
    v_pk_add_f32 v[88:89], v[88:89], v[92:93]
    v_pk_add_f32 v[90:91], v[90:91], v[94:95]
    v_pk_add_f32 v[64:65], v[64:65], v[72:73]
    v_pk_add_f32 v[66:67], v[66:67], v[74:75]
    v_pk_add_f32 v[80:81], v[80:81], v[88:89]
    v_pk_add_f32 v[82:83], v[82:83], v[90:91]
    v_pk_add_f32 v[64:65], v[64:65], v[80:81]
    v_pk_add_f32 v[66:67], v[66:67], v[82:83]
    v_bfi_b32 v64, s77, v64, v12
    v_bfi_b32 v65, s77, v65, v13
    v_bfi_b32 v66, s77, v66, v14
    v_bfi_b32 v67, s77, v67, v15
    s_mov_b64 exec, 0xffffffff
    buffer_store_dwordx4 v[64:67], v59, s[12:15], 0 offen sc1
    s_mov_b64 exec, -1
    s_mov_b32 s46, 1
L_HS9:
    s_waitcnt vmcnt(2)
    buffer_load_dwordx4 v[168:171], v5, s[4:7], s50 offen offset:512 nt
    s_waitcnt vmcnt(2)
    buffer_load_dwordx4 v[172:175], v5, s[4:7], s50 offen offset:640 nt
    s_cmp_lg_u32 s3, 0
    s_cbranch_scc1 L_HS14
    s_cmp_lg_u32 s46, 0
    s_cbranch_scc1 L_HS14
    s_mov_b32 s76, 0
    s_cmp_lg_u32 s47, 0
    s_cbranch_scc1 L_HH15
    s_waitcnt vmcnt(2)
L_HR16:
    v_readfirstlane_b32 s47, v58
    s_cmp_eq_u32 s47, 0
    s_cselect_b32 s47, s96, s47
    s_cmp_lg_u32 s47, 0
    s_cbranch_scc1 L_HG17
    buffer_load_dword v58, off, s[28:31], 0 sc1
    s_branch L_HS14
L_HG17:
    v_mov_b32 v56, 0
    v_mov_b32 v59, s47
    ds_write_b32 v56, v59 offset:10968
L_HH15:
    v_mov_b32 v56, 0
L_HQ18:
    ds_read_b64 v[96:97], v56 offset:10960
    s_waitcnt lgkmcnt(0)
    v_readfirstlane_b32 s64, v96
    v_readfirstlane_b32 s65, v97
    s_add_u32 s64, s64, s65
    s_cmp_eq_u32 s64, 16
    s_cbranch_scc0 L_HS14
    v_and_b32 v56, 1, v3
    v_lshlrev_b32 v59, 11, v56
    v_lshl_add_u32 v59, v4, 4, v59
    ds_read_b128 v[64:67], v59 offset:0
    ds_read_b128 v[68:71], v59 offset:256
    ds_read_b128 v[72:75], v59 offset:512
    ds_read_b128 v[76:79], v59 offset:768
    ds_read_b128 v[80:83], v59 offset:1024
    ds_read_b128 v[84:87], v59 offset:1280
    ds_read_b128 v[88:91], v59 offset:1536
    ds_read_b128 v[92:95], v59 offset:1792
    v_mov_b32 v15, s47
    v_and_b32 v12, 0xff, v15
    v_bfe_u32 v13, v15, 8, 8
    v_bfe_u32 v14, v15, 16, 8
    v_lshrrev_b32 v15, 24, v15
    v_mov_b32 v59, s92
    v_mov_b32 v96, s93
    v_cmp_ne_u32 vcc, 0, v56
    s_nop 1
    v_cndmask_b32 v59, v59, v96, vcc
    v_lshl_add_u32 v59, v4, 4, v59
    s_waitcnt lgkmcnt(0)
    v_pk_add_f32 v[64:65], v[64:65], v[68:69]
    v_pk_add_f32 v[66:67], v[66:67], v[70:71]
    v_pk_add_f32 v[72:73], v[72:73], v[76:77]
    v_pk_add_f32 v[74:75], v[74:75], v[78:79]
    v_pk_add_f32 v[80:81], v[80:81], v[84:85]
    v_pk_add_f32 v[82:83], v[82:83], v[86:87]
    v_pk_add_f32 v[88:89], v[88:89], v[92:93]
    v_pk_add_f32 v[90:91], v[90:91], v[94:95]
    v_pk_add_f32 v[64:65], v[64:65], v[72:73]
    v_pk_add_f32 v[66:67], v[66:67], v[74:75]
    v_pk_add_f32 v[80:81], v[80:81], v[88:89]
    v_pk_add_f32 v[82:83], v[82:83], v[90:91]
    v_pk_add_f32 v[64:65], v[64:65], v[80:81]
    v_pk_add_f32 v[66:67], v[66:67], v[82:83]
    v_bfi_b32 v64, s77, v64, v12
    v_bfi_b32 v65, s77, v65, v13
    v_bfi_b32 v66, s77, v66, v14
    v_bfi_b32 v67, s77, v67, v15
    s_mov_b64 exec, 0xffffffff
    buffer_store_dwordx4 v[64:67], v59, s[12:15], 0 offen sc1
    s_mov_b64 exec, -1
    s_mov_b32 s46, 1
L_HS14:
    s_waitcnt vmcnt(2)
    buffer_load_dwordx4 v[176:179], v5, s[4:7], s51 offen offset:0 nt
    s_waitcnt vmcnt(2)
    buffer_load_dwordx4 v[180:183], v5, s[4:7], s51 offen offset:128 nt
    s_waitcnt vmcnt(2)
    buffer_load_dwordx4 v[184:187], v5, s[4:7], s51 offen offset:512 nt
    s_waitcnt vmcnt(2)
    buffer_load_dwordx4 v[188:191], v5, s[4:7], s51 offen offset:640 nt
    s_cmp_lg_u32 s3, 0
    s_cbranch_scc1 L_HS19
    s_cmp_lg_u32 s46, 0
    s_cbranch_scc1 L_HS19
    s_mov_b32 s76, 0
    s_cmp_lg_u32 s47, 0
    s_cbranch_scc1 L_HH20
    s_waitcnt vmcnt(4)
L_HR21:
    v_readfirstlane_b32 s47, v58
    s_cmp_eq_u32 s47, 0
    s_cselect_b32 s47, s96, s47
    s_cmp_lg_u32 s47, 0
    s_cbranch_scc1 L_HG22
    buffer_load_dword v58, off, s[28:31], 0 sc1
    s_waitcnt vmcnt(0)
    s_add_u32 s76, s76, 1
    s_cmp_lt_u32 s76, 200000
    s_cbranch_scc1 L_HR21
    s_mov_b32 s47, 1
L_HG22:
    v_mov_b32 v56, 0
    v_mov_b32 v59, s47
    ds_write_b32 v56, v59 offset:10968
L_HH20:
    v_mov_b32 v56, 0
L_HQ23:
    ds_read_b64 v[96:97], v56 offset:10960
    s_waitcnt lgkmcnt(0)
    v_readfirstlane_b32 s64, v96
    v_readfirstlane_b32 s65, v97
    s_add_u32 s64, s64, s65
    s_cmp_eq_u32 s64, 16
    s_cbranch_scc1 L_HO24
    s_add_u32 s76, s76, 1
    s_cmp_lt_u32 s76, 4000000
    s_cbranch_scc1 L_HQ23
L_HO24:
    v_and_b32 v56, 1, v3
    v_lshlrev_b32 v59, 11, v56
    v_lshl_add_u32 v59, v4, 4, v59
    ds_read_b128 v[64:67], v59 offset:0
    ds_read_b128 v[68:71], v59 offset:256
    ds_read_b128 v[72:75], v59 offset:512
    ds_read_b128 v[76:79], v59 offset:768
    ds_read_b128 v[80:83], v59 offset:1024
    ds_read_b128 v[84:87], v59 offset:1280
    ds_read_b128 v[88:91], v59 offset:1536
    ds_read_b128 v[92:95], v59 offset:1792
    v_mov_b32 v15, s47
    v_and_b32 v12, 0xff, v15
    v_bfe_u32 v13, v15, 8, 8
    v_bfe_u32 v14, v15, 16, 8
    v_lshrrev_b32 v15, 24, v15
    v_mov_b32 v59, s92
    v_mov_b32 v96, s93
    v_cmp_ne_u32 vcc, 0, v56
    s_nop 1
    v_cndmask_b32 v59, v59, v96, vcc
    v_lshl_add_u32 v59, v4, 4, v59
    s_waitcnt lgkmcnt(0)
    v_pk_add_f32 v[64:65], v[64:65], v[68:69]
    v_pk_add_f32 v[66:67], v[66:67], v[70:71]
    v_pk_add_f32 v[72:73], v[72:73], v[76:77]
    v_pk_add_f32 v[74:75], v[74:75], v[78:79]
    v_pk_add_f32 v[80:81], v[80:81], v[84:85]
    v_pk_add_f32 v[82:83], v[82:83], v[86:87]
    v_pk_add_f32 v[88:89], v[88:89], v[92:93]
    v_pk_add_f32 v[90:91], v[90:91], v[94:95]
    v_pk_add_f32 v[64:65], v[64:65], v[72:73]
    v_pk_add_f32 v[66:67], v[66:67], v[74:75]
    v_pk_add_f32 v[80:81], v[80:81], v[88:89]
    v_pk_add_f32 v[82:83], v[82:83], v[90:91]
    v_pk_add_f32 v[64:65], v[64:65], v[80:81]
    v_pk_add_f32 v[66:67], v[66:67], v[82:83]
    v_bfi_b32 v64, s77, v64, v12
    v_bfi_b32 v65, s77, v65, v13
    v_bfi_b32 v66, s77, v66, v14
    v_bfi_b32 v67, s77, v67, v15
    s_mov_b64 exec, 0xffffffff
    buffer_store_dwordx4 v[64:67], v59, s[12:15], 0 offen sc1
    s_mov_b64 exec, -1
    s_mov_b32 s46, 1
L_HS19:
    s_waitcnt vmcnt(2)
    buffer_load_dwordx4 v[192:195], v5, s[4:7], s52 offen offset:0 nt
    s_waitcnt vmcnt(2)
    buffer_load_dwordx4 v[196:199], v5, s[4:7], s52 offen offset:128 nt
    s_waitcnt vmcnt(2)
    buffer_load_dwordx4 v[200:203], v5, s[4:7], s52 offen offset:512 nt
    s_waitcnt vmcnt(2)
    buffer_load_dwordx4 v[204:207], v5, s[4:7], s52 offen offset:640 nt
    s_waitcnt vmcnt(2)
    buffer_load_dwordx4 v[208:211], v5, s[4:7], s53 offen offset:0 nt
    v_lshlrev_b32 v10, 4, v1
    buffer_load_dwordx4 v[32:35], v10, s[12:15], s82 offen sc1
    buffer_load_dwordx4 v[36:39], v10, s[12:15], s82 offen offset:1024 sc1
    v_and_b32 v11, s101, v1
    v_lshlrev_b32 v11, 8, v11
    v_bfe_u32 v56, v1, 2, 1
    v_lshl_add_u32 v11, v56, 10, v11
    v_lshl_add_u32 v11, v3, 4, v11
    buffer_load_dwordx4 v[40:43], v11, s[12:15], s83 offen sc1
    s_waitcnt vmcnt(2)
    buffer_load_dwordx4 v[212:215], v5, s[4:7], s53 offen offset:128 nt
    s_waitcnt vmcnt(2)
    buffer_load_dwordx4 v[216:219], v5, s[4:7], s53 offen offset:512 nt
    s_waitcnt vmcnt(2)
    buffer_load_dwordx4 v[220:223], v5, s[4:7], s53 offen offset:640 nt
    v_mov_b32 v56, 0
    s_mov_b32 s76, 0
L_SP25:
    ds_read_b32 v59, v56 offset:10968
    s_waitcnt lgkmcnt(0)
    v_readfirstlane_b32 s47, v59
    s_cmp_lg_u32 s47, 0
    s_cbranch_scc1 L_SPD26
    s_sleep 1
    s_add_u32 s76, s76, 1
    s_cmp_lt_u32 s76, 4000000
    s_cbranch_scc1 L_SP25
L_SPD26:
    v_mov_b32 v15, s47
    v_and_b32 v12, 0xff, v15
    v_bfe_u32 v13, v15, 8, 8
    v_bfe_u32 v14, v15, 16, 8
    v_lshrrev_b32 v15, 24, v15
    s_waitcnt vmcnt(3)
    s_mov_b32 s76, 0
L_QL27:
    v_xor_b32 v32, v12, v32
    v_xor_b32 v33, v13, v33
    v_xor_b32 v34, v14, v34
    v_xor_b32 v35, v15, v35
    v_xor_b32 v36, v12, v36
    v_xor_b32 v37, v13, v37
    v_xor_b32 v38, v14, v38
    v_xor_b32 v39, v15, v39
    v_xor_b32 v40, v12, v40
    v_xor_b32 v41, v13, v41
    v_xor_b32 v42, v14, v42
    v_xor_b32 v43, v15, v43
    v_or3_b32 v56, v32, v33, v34
    v_or_b32 v56, v56, v35
    v_or3_b32 v56, v56, v36, v37
    v_or3_b32 v56, v56, v38, v39
    v_or3_b32 v56, v56, v40, v41
    v_or3_b32 v56, v56, v42, v43
    v_and_b32 v56, 0xff, v56
    v_cmp_ne_u32 vcc, 0, v56
    s_mov_b64 exec, -1
    s_cbranch_vccz L_QD28
    s_add_u32 s76, s76, 1
    s_cmp_lt_u32 s76, 200000
    s_cbranch_scc0 L_QD28
    s_sleep 1
    s_mov_b64 exec, vcc
    buffer_load_dwordx4 v[32:35], v10, s[12:15], s82 offen sc1
    buffer_load_dwordx4 v[36:39], v10, s[12:15], s82 offen offset:1024 sc1
    buffer_load_dwordx4 v[40:43], v11, s[12:15], s83 offen sc1
    s_waitcnt vmcnt(0)
    s_branch L_QL27
L_QD28:
    v_pk_add_f32 v[32:33], v[32:33], v[36:37]
    v_pk_add_f32 v[34:35], v[34:35], v[38:39]
    v_mov_b32 v36, v32
    v_mov_b32 v37, v33
    v_mov_b32 v38, v34
    v_mov_b32 v39, v35
    s_nop 1
    v_permlane32_swap_b32 v32, v36
    v_permlane32_swap_b32 v33, v37
    v_permlane32_swap_b32 v34, v38
    v_permlane32_swap_b32 v35, v39
    v_add_f32 v32, v32, v36
    v_add_f32 v33, v33, v37
    v_add_f32 v34, v34, v38
    v_add_f32 v35, v35, v39
    v_cvt_pk_bf16_f32 v32, v32, v33
    v_cvt_pk_bf16_f32 v33, v34, v35
    v_and_b32 v56, 31, v1
    v_lshlrev_b32 v56, 3, v56
    s_mul_i32 s64, s3, 272
    v_add_u32 v56, s64, v56
    ds_write_b64 v56, v[32:33] offset:8192
    v_mov_b32 v56, 0
    v_mov_b32 v59, 1
    s_waitcnt lgkmcnt(0)
    s_mov_b64 exec, 1
    ds_add_u32 v56, v59 offset:10972
    s_mov_b64 exec, -1
    s_nop 1
    v_add_f32_dpp v40, v40, v40 quad_perm:[1,0,3,2] row_mask:0xf bank_mask:0xf
    v_add_f32_dpp v41, v41, v41 quad_perm:[1,0,3,2] row_mask:0xf bank_mask:0xf
    v_add_f32_dpp v42, v42, v42 quad_perm:[1,0,3,2] row_mask:0xf bank_mask:0xf
    v_add_f32_dpp v43, v43, v43 quad_perm:[1,0,3,2] row_mask:0xf bank_mask:0xf
    s_nop 1
    v_add_f32_dpp v40, v40, v40 quad_perm:[2,3,0,1] row_mask:0xf bank_mask:0xf
    v_add_f32_dpp v41, v41, v41 quad_perm:[2,3,0,1] row_mask:0xf bank_mask:0xf
    v_add_f32_dpp v42, v42, v42 quad_perm:[2,3,0,1] row_mask:0xf bank_mask:0xf
    v_add_f32_dpp v43, v43, v43 quad_perm:[2,3,0,1] row_mask:0xf bank_mask:0xf
    v_mul_f32 v40, s100, v40
    v_mul_f32 v41, s100, v41
    v_mul_f32 v42, s100, v42
    v_mul_f32 v43, s100, v43
    v_and_b32 v56, 4, v1
    v_cmp_ne_u32 vcc, 0, v56
    v_mov_b32_dpp v44, v40 row_half_mirror row_mask:0xf bank_mask:0xf
    v_mov_b32_dpp v45, v41 row_half_mirror row_mask:0xf bank_mask:0xf
    v_mov_b32_dpp v46, v42 row_half_mirror row_mask:0xf bank_mask:0xf
    v_mov_b32_dpp v47, v43 row_half_mirror row_mask:0xf bank_mask:0xf
    v_cndmask_b32 v32, v40, v44, vcc
    v_cndmask_b32 v33, v41, v45, vcc
    v_cndmask_b32 v34, v42, v46, vcc
    v_cndmask_b32 v35, v43, v47, vcc
    v_cndmask_b32 v44, v44, v40, vcc
    v_cndmask_b32 v45, v45, v41, vcc
    v_cndmask_b32 v46, v46, v42, vcc
    v_cndmask_b32 v47, v47, v43, vcc
    v_cvt_pk_bf16_f32 v32, v32, v33
    v_cvt_pk_bf16_f32 v33, v34, v35
    v_cvt_pk_bf16_f32 v44, v44, v45
    v_cvt_pk_bf16_f32 v45, v46, v47
    v_lshlrev_b32 v36, 16, v32
    v_and_b32 v37, 0xffff0000, v32
    v_lshlrev_b32 v38, 16, v33
    v_and_b32 v39, 0xffff0000, v33
    v_mul_f32 v40, 0xbfb8aa3b, v36
    v_mul_f32 v41, 0xbfb8aa3b, v37
    v_mul_f32 v42, 0xbfb8aa3b, v38
    v_mul_f32 v43, 0xbfb8aa3b, v39
    v_exp_f32 v40, v40
    v_exp_f32 v41, v41
    v_exp_f32 v42, v42
    v_exp_f32 v43, v43
    s_nop 0
    v_add_f32 v40, 1.0, v40
    v_add_f32 v41, 1.0, v41
    v_add_f32 v42, 1.0, v42
    v_add_f32 v43, 1.0, v43
    v_rcp_f32 v40, v40
    v_rcp_f32 v41, v41
    v_rcp_f32 v42, v42
    v_rcp_f32 v43, v43
    s_nop 0
    v_mul_f32 v36, v36, v40
    v_mul_f32 v37, v37, v41
    v_mul_f32 v38, v38, v42
    v_mul_f32 v39, v39, v43
    v_cvt_pk_bf16_f32 v32, v36, v37
    v_cvt_pk_bf16_f32 v33, v38, v39
    v_lshlrev_b32 v36, 16, v32
    v_and_b32 v37, 0xffff0000, v32
    v_lshlrev_b32 v38, 16, v33
    v_and_b32 v39, 0xffff0000, v33
    v_lshlrev_b32 v40, 16, v44
    v_and_b32 v41, 0xffff0000, v44
    v_lshlrev_b32 v42, 16, v45
    v_and_b32 v43, 0xffff0000, v45
    v_mul_f32 v36, v36, v40
    v_mul_f32 v37, v37, v41
    v_mul_f32 v38, v38, v42
    v_mul_f32 v39, v39, v43
    v_cvt_pk_bf16_f32 v62, v36, v37
    v_cvt_pk_bf16_f32 v63, v38, v39
    s_waitcnt vmcnt(2)
    buffer_load_dwordx4 v[224:227], v5, s[4:7], s54 offen offset:0 nt
    s_waitcnt vmcnt(2)
    buffer_load_dwordx4 v[228:231], v5, s[4:7], s54 offen offset:128 nt
    s_waitcnt vmcnt(2)
    buffer_load_dwordx4 v[232:235], v5, s[4:7], s54 offen offset:512 nt
    s_waitcnt vmcnt(2)
    buffer_load_dwordx4 v[236:239], v5, s[4:7], s54 offen offset:640 nt
    s_waitcnt vmcnt(2)
    buffer_load_dwordx4 v[240:243], v5, s[4:7], s55 offen offset:0 nt
    s_waitcnt vmcnt(2)
    buffer_load_dwordx4 v[244:247], v5, s[4:7], s55 offen offset:128 nt
    s_waitcnt vmcnt(2)
    buffer_load_dwordx4 v[248:251], v5, s[4:7], s55 offen offset:512 nt
    s_waitcnt vmcnt(2)
    buffer_load_dwordx4 v[252:255], v5, s[4:7], s55 offen offset:640 nt
    s_waitcnt vmcnt(2)
    buffer_load_dwordx4 v[64:67], v6, s[8:11], s48 offen offset:0 nt
    s_waitcnt vmcnt(2)
    buffer_load_dwordx4 v[68:71], v6, s[8:11], s48 offen offset:256 nt
    s_waitcnt vmcnt(2)
    buffer_load_dwordx4 v[72:75], v6, s[8:11], s48 offen offset:512 nt
    v_and_b32 v10, 7, v1
    v_mul_u32_u24 v10, 272, v10
    v_bfe_u32 v11, v1, 3, 1
    v_lshl_add_u32 v10, v11, 4, v10
    v_lshl_add_u32 v10, v3, 5, v10
    v_mov_b32 v61, 0xffff
    v_lshlrev_b32 v11, 4, v11
    v_lshlrev_b32 v61, v11, v61
    v_lshlrev_b32 v2, 13, v3
    v_lshl_add_u32 v2, v4, 4, v2
    v_mov_b32 v56, 0
    s_mov_b32 s76, 0
L_SP29:
    ds_read_b32 v59, v56 offset:10972
    s_waitcnt lgkmcnt(0)
    v_readfirstlane_b32 s64, v59
    s_cmp_ge_u32 s64, 8
    s_cbranch_scc1 L_SPD30
    s_sleep 1
    s_add_u32 s76, s76, 1
    s_cmp_lt_u32 s76, 4000000
    s_cbranch_scc1 L_SP29
L_SPD30:
    ds_read_b128 v[48:51], v10 offset:8192
    ds_read_b128 v[52:55], v10 offset:8320
    s_waitcnt lgkmcnt(0)
    s_waitcnt vmcnt(34)
    v_mfma_f32_16x16x32_bf16 v[32:35], v[128:131], v[48:51], 0
    v_mfma_f32_16x16x32_bf16 v[36:39], v[136:139], v[48:51], 0
    v_mfma_f32_16x16x32_bf16 v[32:35], v[132:135], v[52:55], v[32:35]
    v_mfma_f32_16x16x32_bf16 v[36:39], v[140:143], v[52:55], v[36:39]
    s_waitcnt vmcnt(30)
    v_mfma_f32_16x16x32_bf16 v[40:43], v[144:147], v[48:51], 0
    v_mfma_f32_16x16x32_bf16 v[44:47], v[152:155], v[48:51], 0
    v_mfma_f32_16x16x32_bf16 v[40:43], v[148:151], v[52:55], v[40:43]
    v_mfma_f32_16x16x32_bf16 v[44:47], v[156:159], v[52:55], v[44:47]
    s_nop 3
    v_add_f32_dpp v16, v33, v32 row_ror:8 row_mask:0xf bank_mask:0x3
    v_add_f32_dpp v16, v34, v35 row_ror:8 row_mask:0xf bank_mask:0xc
    v_add_f32_dpp v17, v37, v36 row_ror:8 row_mask:0xf bank_mask:0x3
    v_add_f32_dpp v17, v38, v39 row_ror:8 row_mask:0xf bank_mask:0xc
    s_waitcnt vmcnt(2)
    buffer_load_dwordx4 v[76:79], v6, s[8:11], s48 offen offset:768 nt
    s_waitcnt vmcnt(27)
    v_mfma_f32_16x16x32_bf16 v[32:35], v[160:163], v[48:51], 0
    v_mfma_f32_16x16x32_bf16 v[36:39], v[168:171], v[48:51], 0
    v_mfma_f32_16x16x32_bf16 v[32:35], v[164:167], v[52:55], v[32:35]
    v_mfma_f32_16x16x32_bf16 v[36:39], v[172:175], v[52:55], v[36:39]
    v_add_f32_dpp v18, v41, v40 row_ror:8 row_mask:0xf bank_mask:0x3
    v_add_f32_dpp v18, v42, v43 row_ror:8 row_mask:0xf bank_mask:0xc
    v_add_f32_dpp v19, v45, v44 row_ror:8 row_mask:0xf bank_mask:0x3
    v_add_f32_dpp v19, v46, v47 row_ror:8 row_mask:0xf bank_mask:0xc
    s_waitcnt vmcnt(23)
    v_mfma_f32_16x16x32_bf16 v[40:43], v[176:179], v[48:51], 0
    v_mfma_f32_16x16x32_bf16 v[44:47], v[184:187], v[48:51], 0
    v_mfma_f32_16x16x32_bf16 v[40:43], v[180:183], v[52:55], v[40:43]
    v_mfma_f32_16x16x32_bf16 v[44:47], v[188:191], v[52:55], v[44:47]
    v_add_f32_dpp v20, v33, v32 row_ror:8 row_mask:0xf bank_mask:0x3
    v_add_f32_dpp v20, v34, v35 row_ror:8 row_mask:0xf bank_mask:0xc
    v_add_f32_dpp v21, v37, v36 row_ror:8 row_mask:0xf bank_mask:0x3
    v_add_f32_dpp v21, v38, v39 row_ror:8 row_mask:0xf bank_mask:0xc
    s_waitcnt vmcnt(2)
    buffer_load_dwordx4 v[80:83], v6, s[8:11], s49 offen offset:0 nt
    s_waitcnt vmcnt(20)
    v_mfma_f32_16x16x32_bf16 v[32:35], v[192:195], v[48:51], 0
    v_mfma_f32_16x16x32_bf16 v[36:39], v[200:203], v[48:51], 0
    v_mfma_f32_16x16x32_bf16 v[32:35], v[196:199], v[52:55], v[32:35]
    v_mfma_f32_16x16x32_bf16 v[36:39], v[204:207], v[52:55], v[36:39]
    v_add_f32_dpp v22, v41, v40 row_ror:8 row_mask:0xf bank_mask:0x3
    v_add_f32_dpp v22, v42, v43 row_ror:8 row_mask:0xf bank_mask:0xc
    v_add_f32_dpp v23, v45, v44 row_ror:8 row_mask:0xf bank_mask:0x3
    v_add_f32_dpp v23, v46, v47 row_ror:8 row_mask:0xf bank_mask:0xc
    s_waitcnt vmcnt(13)
    v_mfma_f32_16x16x32_bf16 v[40:43], v[208:211], v[48:51], 0
    v_mfma_f32_16x16x32_bf16 v[44:47], v[216:219], v[48:51], 0
    v_mfma_f32_16x16x32_bf16 v[40:43], v[212:215], v[52:55], v[40:43]
    v_mfma_f32_16x16x32_bf16 v[44:47], v[220:223], v[52:55], v[44:47]
    v_add_f32_dpp v24, v33, v32 row_ror:8 row_mask:0xf bank_mask:0x3
    v_add_f32_dpp v24, v34, v35 row_ror:8 row_mask:0xf bank_mask:0xc
    v_add_f32_dpp v25, v37, v36 row_ror:8 row_mask:0xf bank_mask:0x3
    v_add_f32_dpp v25, v38, v39 row_ror:8 row_mask:0xf bank_mask:0xc
    s_waitcnt vmcnt(2)
    buffer_load_dwordx4 v[84:87], v6, s[8:11], s49 offen offset:256 nt
    s_waitcnt vmcnt(10)
    v_mfma_f32_16x16x32_bf16 v[32:35], v[224:227], v[48:51], 0
    v_mfma_f32_16x16x32_bf16 v[36:39], v[232:235], v[48:51], 0
    v_mfma_f32_16x16x32_bf16 v[32:35], v[228:231], v[52:55], v[32:35]
    v_mfma_f32_16x16x32_bf16 v[36:39], v[236:239], v[52:55], v[36:39]
    v_add_f32_dpp v26, v41, v40 row_ror:8 row_mask:0xf bank_mask:0x3
    v_add_f32_dpp v26, v42, v43 row_ror:8 row_mask:0xf bank_mask:0xc
    v_add_f32_dpp v27, v45, v44 row_ror:8 row_mask:0xf bank_mask:0x3
    v_add_f32_dpp v27, v46, v47 row_ror:8 row_mask:0xf bank_mask:0xc
    s_waitcnt vmcnt(6)
    v_mfma_f32_16x16x32_bf16 v[40:43], v[240:243], v[48:51], 0
    v_mfma_f32_16x16x32_bf16 v[44:47], v[248:251], v[48:51], 0
    v_mfma_f32_16x16x32_bf16 v[40:43], v[244:247], v[52:55], v[40:43]
    v_mfma_f32_16x16x32_bf16 v[44:47], v[252:255], v[52:55], v[44:47]
    v_add_f32_dpp v28, v33, v32 row_ror:8 row_mask:0xf bank_mask:0x3
    v_add_f32_dpp v28, v34, v35 row_ror:8 row_mask:0xf bank_mask:0xc
    v_add_f32_dpp v29, v37, v36 row_ror:8 row_mask:0xf bank_mask:0x3
    v_add_f32_dpp v29, v38, v39 row_ror:8 row_mask:0xf bank_mask:0xc
    s_waitcnt vmcnt(2)
    buffer_load_dwordx4 v[88:91], v6, s[8:11], s49 offen offset:512 nt
    s_nop 7
    v_add_f32_dpp v30, v41, v40 row_ror:8 row_mask:0xf bank_mask:0x3
    v_add_f32_dpp v30, v42, v43 row_ror:8 row_mask:0xf bank_mask:0xc
    v_add_f32_dpp v31, v45, v44 row_ror:8 row_mask:0xf bank_mask:0x3
    v_add_f32_dpp v31, v46, v47 row_ror:8 row_mask:0xf bank_mask:0xc
    v_mov_b32 v192, 0
    v_mov_b32 v193, 0
    v_mov_b32 v194, 0
    v_mov_b32 v195, 0
    v_mov_b32 v196, 0
    v_mov_b32 v197, 0
    v_mov_b32 v198, 0
    v_mov_b32 v199, 0
    v_mov_b32 v200, 0
    v_mov_b32 v201, 0
    v_mov_b32 v202, 0
    v_mov_b32 v203, 0
    v_mov_b32 v204, 0
    v_mov_b32 v205, 0
    v_mov_b32 v206, 0
    v_mov_b32 v207, 0
    v_mov_b32 v208, 0
    v_mov_b32 v209, 0
    v_mov_b32 v210, 0
    v_mov_b32 v211, 0
    v_mov_b32 v212, 0
    v_mov_b32 v213, 0
    v_mov_b32 v214, 0
    v_mov_b32 v215, 0
    v_mov_b32 v216, 0
    v_mov_b32 v217, 0
    v_mov_b32 v218, 0
    v_mov_b32 v219, 0
    v_mov_b32 v220, 0
    v_mov_b32 v221, 0
    v_mov_b32 v222, 0
    v_mov_b32 v223, 0
    s_waitcnt vmcnt(2)
    buffer_load_dwordx4 v[92:95], v6, s[8:11], s49 offen offset:768 nt
    v_max3_f32 v8, v16, v17, v18
    v_max3_f32 v8, v8, v19, v20
    v_max3_f32 v8, v8, v21, v22
    v_max3_f32 v8, v8, v23, v24
    v_max3_f32 v8, v8, v25, v26
    v_max3_f32 v8, v8, v27, v28
    v_max3_f32 v8, v8, v29, v30
    v_max_f32 v8, v8, v31
    s_nop 1
    v_max_f32_dpp v8, v8, v8 row_ror:8 row_mask:0xf bank_mask:0xf
    v_mov_b32 v10, v8
    s_nop 1
    v_permlane16_swap_b32 v8, v10
    v_max_f32 v8, v8, v10
    v_mov_b32 v10, v8
    s_nop 1
    v_permlane32_swap_b32 v8, v10
    v_max_f32 v8, v8, v10
    v_mul_f32 v8, 0x3e0293ee, v8
    v_mov_b32 v11, 0x3e0293ee
    v_mov_b32 v9, 0
    v_and_b32 v10, 7, v1
    v_lshlrev_b32 v10, 5, v10
    s_lshl_b32 s64, s3, 2
    v_add_u32 v60, s64, v10
    ds_write_b32 v60, v8 offset:10368
    v_fma_f32 v16, v16, v11, -v8
    v_fma_f32 v17, v17, v11, -v8
    v_fma_f32 v18, v18, v11, -v8
    v_fma_f32 v19, v19, v11, -v8
    v_fma_f32 v20, v20, v11, -v8
    v_fma_f32 v21, v21, v11, -v8
    v_fma_f32 v22, v22, v11, -v8
    v_fma_f32 v23, v23, v11, -v8
    v_fma_f32 v24, v24, v11, -v8
    v_fma_f32 v25, v25, v11, -v8
    v_fma_f32 v26, v26, v11, -v8
    v_fma_f32 v27, v27, v11, -v8
    v_fma_f32 v28, v28, v11, -v8
    v_fma_f32 v29, v29, v11, -v8
    v_fma_f32 v30, v30, v11, -v8
    v_fma_f32 v31, v31, v11, -v8
    v_mov_b32 v56, 0
    v_mov_b32 v59, 1
    s_waitcnt lgkmcnt(0)
    s_mov_b64 exec, 1
    ds_add_u32 v56, v59 offset:10976
    s_mov_b64 exec, -1
    s_waitcnt vmcnt(2)
    buffer_load_dwordx4 v[96:99], v6, s[8:11], s50 offen offset:0 nt
    v_exp_f32 v16, v16
    v_exp_f32 v17, v17
    v_exp_f32 v18, v18
    v_exp_f32 v19, v19
    v_exp_f32 v20, v20
    v_exp_f32 v21, v21
    v_exp_f32 v22, v22
    v_exp_f32 v23, v23
    v_exp_f32 v24, v24
    v_exp_f32 v25, v25
    v_exp_f32 v26, v26
    v_exp_f32 v27, v27
    v_exp_f32 v28, v28
    v_exp_f32 v29, v29
    v_exp_f32 v30, v30
    v_exp_f32 v31, v31
    s_nop 0
    v_cvt_pk_bf16_f32 v240, v16, v16
    v_cvt_pk_bf16_f32 v241, v17, v17
    v_cvt_pk_bf16_f32 v242, v18, v18
    v_cvt_pk_bf16_f32 v243, v19, v19
    v_cvt_pk_bf16_f32 v244, v20, v20
    v_cvt_pk_bf16_f32 v245, v21, v21
    v_cvt_pk_bf16_f32 v246, v22, v22
    v_cvt_pk_bf16_f32 v247, v23, v23
    v_cvt_pk_bf16_f32 v248, v24, v24
    v_cvt_pk_bf16_f32 v249, v25, v25
    v_cvt_pk_bf16_f32 v250, v26, v26
    v_cvt_pk_bf16_f32 v251, v27, v27
    v_cvt_pk_bf16_f32 v252, v28, v28
    v_cvt_pk_bf16_f32 v253, v29, v29
    v_cvt_pk_bf16_f32 v254, v30, v30
    v_cvt_pk_bf16_f32 v255, v31, v31
    s_waitcnt vmcnt(2)
    buffer_load_dwordx4 v[100:103], v6, s[8:11], s50 offen offset:256 nt
    v_and_b32 v240, v61, v240
    v_and_b32 v241, v61, v241
    v_and_b32 v242, v61, v242
    v_and_b32 v243, v61, v243
    v_and_b32 v244, v61, v244
    v_and_b32 v245, v61, v245
    v_and_b32 v246, v61, v246
    v_and_b32 v247, v61, v247
    v_and_b32 v248, v61, v248
    v_and_b32 v249, v61, v249
    v_and_b32 v250, v61, v250
    v_and_b32 v251, v61, v251
    v_and_b32 v252, v61, v252
    v_and_b32 v253, v61, v253
    v_and_b32 v254, v61, v254
    v_and_b32 v255, v61, v255
    v_dot2c_f32_bf16 v9, s81, v240
    v_dot2c_f32_bf16 v9, s81, v241
    v_dot2c_f32_bf16 v9, s81, v242
    v_dot2c_f32_bf16 v9, s81, v243
    v_dot2c_f32_bf16 v9, s81, v244
    v_dot2c_f32_bf16 v9, s81, v245
    v_dot2c_f32_bf16 v9, s81, v246
    v_dot2c_f32_bf16 v9, s81, v247
    v_dot2c_f32_bf16 v9, s81, v248
    v_dot2c_f32_bf16 v9, s81, v249
    v_dot2c_f32_bf16 v9, s81, v250
    v_dot2c_f32_bf16 v9, s81, v251
    v_dot2c_f32_bf16 v9, s81, v252
    v_dot2c_f32_bf16 v9, s81, v253
    v_dot2c_f32_bf16 v9, s81, v254
    v_dot2c_f32_bf16 v9, s81, v255
    s_nop 1
    s_nop 1
    v_add_f32_dpp v9, v9, v9 row_ror:8 row_mask:0xf bank_mask:0xf
    v_mov_b32 v10, v9
    s_nop 1
    v_permlane16_swap_b32 v9, v10
    v_add_f32 v9, v9, v10
    v_mov_b32 v10, v9
    s_nop 1
    v_permlane32_swap_b32 v9, v10
    v_add_f32 v9, v9, v10
    s_waitcnt vmcnt(2)
    buffer_load_dwordx4 v[104:107], v6, s[8:11], s50 offen offset:512 nt
    s_waitcnt vmcnt(3)
    v_perm_b32 v224, v68, v64, s72
    v_perm_b32 v228, v68, v64, s73
    v_perm_b32 v225, v76, v72, s72
    v_perm_b32 v229, v76, v72, s73
    v_perm_b32 v226, v84, v80, s72
    v_perm_b32 v230, v84, v80, s73
    v_perm_b32 v227, v92, v88, s72
    v_perm_b32 v231, v92, v88, s73
    s_nop 1
    v_mfma_f32_16x16x32_bf16 v[192:195], v[224:227], v[240:243], v[192:195]
    v_mfma_f32_16x16x32_bf16 v[196:199], v[228:231], v[240:243], v[196:199]
    v_perm_b32 v232, v69, v65, s72
    v_perm_b32 v236, v69, v65, s73
    v_perm_b32 v233, v77, v73, s72
    v_perm_b32 v237, v77, v73, s73
    v_perm_b32 v234, v85, v81, s72
    v_perm_b32 v238, v85, v81, s73
    v_perm_b32 v235, v93, v89, s72
    v_perm_b32 v239, v93, v89, s73
    s_nop 1
    v_mfma_f32_16x16x32_bf16 v[200:203], v[232:235], v[240:243], v[200:203]
    v_mfma_f32_16x16x32_bf16 v[204:207], v[236:239], v[240:243], v[204:207]
    s_waitcnt vmcnt(2)
    buffer_load_dwordx4 v[108:111], v6, s[8:11], s50 offen offset:768 nt
    v_perm_b32 v224, v70, v66, s72
    v_perm_b32 v228, v70, v66, s73
    v_perm_b32 v225, v78, v74, s72
    v_perm_b32 v229, v78, v74, s73
    v_perm_b32 v226, v86, v82, s72
    v_perm_b32 v230, v86, v82, s73
    v_perm_b32 v227, v94, v90, s72
    v_perm_b32 v231, v94, v90, s73
    s_nop 1
    v_mfma_f32_16x16x32_bf16 v[208:211], v[224:227], v[240:243], v[208:211]
    v_mfma_f32_16x16x32_bf16 v[212:215], v[228:231], v[240:243], v[212:215]
    v_perm_b32 v232, v71, v67, s72
    v_perm_b32 v236, v71, v67, s73
    v_perm_b32 v233, v79, v75, s72
    v_perm_b32 v237, v79, v75, s73
    v_perm_b32 v234, v87, v83, s72
    v_perm_b32 v238, v87, v83, s73
    v_perm_b32 v235, v95, v91, s72
    v_perm_b32 v239, v95, v91, s73
    s_nop 1
    v_mfma_f32_16x16x32_bf16 v[216:219], v[232:235], v[240:243], v[216:219]
    v_mfma_f32_16x16x32_bf16 v[220:223], v[236:239], v[240:243], v[220:223]
    s_waitcnt vmcnt(2)
    buffer_load_dwordx4 v[112:115], v6, s[8:11], s51 offen offset:0 nt
    s_waitcnt vmcnt(2)
    buffer_load_dwordx4 v[116:119], v6, s[8:11], s51 offen offset:256 nt
    s_waitcnt vmcnt(2)
    buffer_load_dwordx4 v[120:123], v6, s[8:11], s51 offen offset:512 nt
    s_waitcnt vmcnt(2)
    buffer_load_dwordx4 v[124:127], v6, s[8:11], s51 offen offset:768 nt
    s_waitcnt vmcnt(2)
    buffer_load_dwordx4 v[128:131], v6, s[8:11], s52 offen offset:0 nt
    s_waitcnt vmcnt(2)
    buffer_load_dwordx4 v[132:135], v6, s[8:11], s52 offen offset:256 nt
    s_waitcnt vmcnt(2)
    buffer_load_dwordx4 v[136:139], v6, s[8:11], s52 offen offset:512 nt
    s_waitcnt vmcnt(3)
    v_perm_b32 v224, v100, v96, s72
    v_perm_b32 v228, v100, v96, s73
    v_perm_b32 v225, v108, v104, s72
    v_perm_b32 v229, v108, v104, s73
    v_perm_b32 v226, v116, v112, s72
    v_perm_b32 v230, v116, v112, s73
    v_perm_b32 v227, v124, v120, s72
    v_perm_b32 v231, v124, v120, s73
    s_nop 1
    v_mfma_f32_16x16x32_bf16 v[192:195], v[224:227], v[244:247], v[192:195]
    v_mfma_f32_16x16x32_bf16 v[196:199], v[228:231], v[244:247], v[196:199]
    v_perm_b32 v232, v101, v97, s72
    v_perm_b32 v236, v101, v97, s73
    v_perm_b32 v233, v109, v105, s72
    v_perm_b32 v237, v109, v105, s73
    v_perm_b32 v234, v117, v113, s72
    v_perm_b32 v238, v117, v113, s73
    v_perm_b32 v235, v125, v121, s72
    v_perm_b32 v239, v125, v121, s73
    s_nop 1
    v_mfma_f32_16x16x32_bf16 v[200:203], v[232:235], v[244:247], v[200:203]
    v_mfma_f32_16x16x32_bf16 v[204:207], v[236:239], v[244:247], v[204:207]
    s_waitcnt vmcnt(2)
    buffer_load_dwordx4 v[140:143], v6, s[8:11], s52 offen offset:768 nt
    v_perm_b32 v224, v102, v98, s72
    v_perm_b32 v228, v102, v98, s73
    v_perm_b32 v225, v110, v106, s72
    v_perm_b32 v229, v110, v106, s73
    v_perm_b32 v226, v118, v114, s72
    v_perm_b32 v230, v118, v114, s73
    v_perm_b32 v227, v126, v122, s72
    v_perm_b32 v231, v126, v122, s73
    s_nop 1
    v_mfma_f32_16x16x32_bf16 v[208:211], v[224:227], v[244:247], v[208:211]
    v_mfma_f32_16x16x32_bf16 v[212:215], v[228:231], v[244:247], v[212:215]
    v_perm_b32 v232, v103, v99, s72
    v_perm_b32 v236, v103, v99, s73
    v_perm_b32 v233, v111, v107, s72
    v_perm_b32 v237, v111, v107, s73
    v_perm_b32 v234, v119, v115, s72
    v_perm_b32 v238, v119, v115, s73
    v_perm_b32 v235, v127, v123, s72
    v_perm_b32 v239, v127, v123, s73
    s_nop 1
    v_mfma_f32_16x16x32_bf16 v[216:219], v[232:235], v[244:247], v[216:219]
    v_mfma_f32_16x16x32_bf16 v[220:223], v[236:239], v[244:247], v[220:223]
    s_waitcnt vmcnt(2)
    buffer_load_dwordx4 v[144:147], v6, s[8:11], s53 offen offset:0 nt
    s_waitcnt vmcnt(2)
    buffer_load_dwordx4 v[148:151], v6, s[8:11], s53 offen offset:256 nt
    s_waitcnt vmcnt(2)
    buffer_load_dwordx4 v[152:155], v6, s[8:11], s53 offen offset:512 nt
    s_waitcnt vmcnt(2)
    buffer_load_dwordx4 v[156:159], v6, s[8:11], s53 offen offset:768 nt
    s_waitcnt vmcnt(2)
    buffer_load_dwordx4 v[160:163], v6, s[8:11], s54 offen offset:0 nt
    s_waitcnt vmcnt(2)
    buffer_load_dwordx4 v[164:167], v6, s[8:11], s54 offen offset:256 nt
    s_waitcnt vmcnt(2)
    buffer_load_dwordx4 v[168:171], v6, s[8:11], s54 offen offset:512 nt
    s_waitcnt vmcnt(3)
    v_perm_b32 v224, v132, v128, s72
    v_perm_b32 v228, v132, v128, s73
    v_perm_b32 v225, v140, v136, s72
    v_perm_b32 v229, v140, v136, s73
    v_perm_b32 v226, v148, v144, s72
    v_perm_b32 v230, v148, v144, s73
    v_perm_b32 v227, v156, v152, s72
    v_perm_b32 v231, v156, v152, s73
    s_nop 1
    v_mfma_f32_16x16x32_bf16 v[192:195], v[224:227], v[248:251], v[192:195]
    v_mfma_f32_16x16x32_bf16 v[196:199], v[228:231], v[248:251], v[196:199]
    v_perm_b32 v232, v133, v129, s72
    v_perm_b32 v236, v133, v129, s73
    v_perm_b32 v233, v141, v137, s72
    v_perm_b32 v237, v141, v137, s73
    v_perm_b32 v234, v149, v145, s72
    v_perm_b32 v238, v149, v145, s73
    v_perm_b32 v235, v157, v153, s72
    v_perm_b32 v239, v157, v153, s73
    s_nop 1
    v_mfma_f32_16x16x32_bf16 v[200:203], v[232:235], v[248:251], v[200:203]
    v_mfma_f32_16x16x32_bf16 v[204:207], v[236:239], v[248:251], v[204:207]
    s_waitcnt vmcnt(2)
    buffer_load_dwordx4 v[172:175], v6, s[8:11], s54 offen offset:768 nt
    v_perm_b32 v224, v134, v130, s72
    v_perm_b32 v228, v134, v130, s73
    v_perm_b32 v225, v142, v138, s72
    v_perm_b32 v229, v142, v138, s73
    v_perm_b32 v226, v150, v146, s72
    v_perm_b32 v230, v150, v146, s73
    v_perm_b32 v227, v158, v154, s72
    v_perm_b32 v231, v158, v154, s73
    s_nop 1
    v_mfma_f32_16x16x32_bf16 v[208:211], v[224:227], v[248:251], v[208:211]
    v_mfma_f32_16x16x32_bf16 v[212:215], v[228:231], v[248:251], v[212:215]
    v_perm_b32 v232, v135, v131, s72
    v_perm_b32 v236, v135, v131, s73
    v_perm_b32 v233, v143, v139, s72
    v_perm_b32 v237, v143, v139, s73
    v_perm_b32 v234, v151, v147, s72
    v_perm_b32 v238, v151, v147, s73
    v_perm_b32 v235, v159, v155, s72
    v_perm_b32 v239, v159, v155, s73
    s_nop 1
    v_mfma_f32_16x16x32_bf16 v[216:219], v[232:235], v[248:251], v[216:219]
    v_mfma_f32_16x16x32_bf16 v[220:223], v[236:239], v[248:251], v[220:223]
    s_waitcnt vmcnt(2)
    buffer_load_dwordx4 v[176:179], v6, s[8:11], s55 offen offset:0 nt
    s_waitcnt vmcnt(2)
    buffer_load_dwordx4 v[180:183], v6, s[8:11], s55 offen offset:256 nt
    s_waitcnt vmcnt(2)
    buffer_load_dwordx4 v[184:187], v6, s[8:11], s55 offen offset:512 nt
    s_waitcnt vmcnt(2)
    buffer_load_dwordx4 v[188:191], v6, s[8:11], s55 offen offset:768 nt
    v_lshrrev_b32 v115, 5, v1
    v_mul_u32_u24 v115, 17408, v115
    v_and_b32 v116, 31, v1
    v_lshl_add_u32 v115, v116, 4, v115
    s_mul_i32 s65, s3, 544
    v_add_u32 v115, s65, v115
    v_and_b32 v117, 7, v1
    v_lshlrev_b32 v118, 10, v117
    v_lshlrev_b32 v117, 5, v117
    v_lshrrev_b32 v119, 2, v116
    v_lshlrev_b32 v119, 12, v119
    v_and_b32 v116, 3, v1
    v_lshl_add_u32 v119, v116, 4, v119
    s_lshl_b32 s67, s44, 18
    s_lshl_b32 s65, s45, 6
    s_add_u32 s67, s67, s65
    s_lshl_b32 s65, s3, 15
    s_add_u32 s67, s67, s65
    s_add_u32 s67, s67, 1048576
    s_lshl_b32 s66, s44, 13
    s_lshl_b32 s65, s45, 4
    s_add_u32 s66, s66, s65
    s_add_u32 s66, s66, 262144
    s_lshl_b32 s94, 1, s3
    s_mov_b32 s95, 0
    v_mov_b32 v146, s47
    v_mov_b32 v147, s47
    v_and_b32 v11, 7, v1
    v_mul_u32_u24 v11, 544, v11
    v_bfe_u32 v109, v1, 3, 1
    v_lshl_add_u32 v11, v109, 4, v11
    v_lshl_add_u32 v11, v3, 7, v11
    s_mul_i32 s64, s3, 4352
    v_add_u32 v11, s64, v11
    v_mov_b32 v116, 1
    s_waitcnt vmcnt(0)
    v_mov_b32 v56, 0
    v_and_b32 v10, 7, v1
    v_lshlrev_b32 v10, 5, v10
    ds_read_b32 v59, v56 offset:10976
    ds_read_b128 v[100:103], v10 offset:10368
    ds_read_b128 v[104:107], v10 offset:10384
    v_perm_b32 v224, v164, v160, s72
    v_perm_b32 v228, v164, v160, s73
    v_perm_b32 v225, v172, v168, s72
    v_perm_b32 v229, v172, v168, s73
    v_perm_b32 v226, v180, v176, s72
    v_perm_b32 v230, v180, v176, s73
    v_perm_b32 v227, v188, v184, s72
    v_perm_b32 v231, v188, v184, s73
    s_nop 1
    v_mfma_f32_16x16x32_bf16 v[192:195], v[224:227], v[252:255], v[192:195]
    v_mfma_f32_16x16x32_bf16 v[196:199], v[228:231], v[252:255], v[196:199]
    v_perm_b32 v232, v165, v161, s72
    v_perm_b32 v236, v165, v161, s73
    v_perm_b32 v233, v173, v169, s72
    v_perm_b32 v237, v173, v169, s73
    v_perm_b32 v234, v181, v177, s72
    v_perm_b32 v238, v181, v177, s73
    v_perm_b32 v235, v189, v185, s72
    v_perm_b32 v239, v189, v185, s73
    s_nop 1
    v_mfma_f32_16x16x32_bf16 v[200:203], v[232:235], v[252:255], v[200:203]
    v_mfma_f32_16x16x32_bf16 v[204:207], v[236:239], v[252:255], v[204:207]
    v_perm_b32 v224, v166, v162, s72
    v_perm_b32 v228, v166, v162, s73
    v_perm_b32 v225, v174, v170, s72
    v_perm_b32 v229, v174, v170, s73
    v_perm_b32 v226, v182, v178, s72
    v_perm_b32 v230, v182, v178, s73
    v_perm_b32 v227, v190, v186, s72
    v_perm_b32 v231, v190, v186, s73
    s_nop 1
    v_mfma_f32_16x16x32_bf16 v[208:211], v[224:227], v[252:255], v[208:211]
    v_mfma_f32_16x16x32_bf16 v[212:215], v[228:231], v[252:255], v[212:215]
    v_perm_b32 v232, v167, v163, s72
    v_perm_b32 v236, v167, v163, s73
    v_perm_b32 v233, v175, v171, s72
    v_perm_b32 v237, v175, v171, s73
    v_perm_b32 v234, v183, v179, s72
    v_perm_b32 v238, v183, v179, s73
    v_perm_b32 v235, v191, v187, s72
    v_perm_b32 v239, v191, v187, s73
    s_nop 1
    v_mfma_f32_16x16x32_bf16 v[216:219], v[232:235], v[252:255], v[216:219]
    v_mfma_f32_16x16x32_bf16 v[220:223], v[236:239], v[252:255], v[220:223]
    s_mov_b32 s76, 0
L_MS31:
    s_waitcnt lgkmcnt(0)
    v_readfirstlane_b32 s64, v59
    s_cmp_ge_u32 s64, 8
    s_cbranch_scc1 L_MD32
    s_add_u32 s76, s76, 1
    s_cmp_lt_u32 s76, 4000000
    s_cbranch_scc0 L_MD32
    ds_read_b32 v59, v56 offset:10976
    ds_read_b128 v[100:103], v10 offset:10368
    ds_read_b128 v[104:107], v10 offset:10384
    s_branch L_MS31
L_MD32:
    v_max3_f32 v10, v100, v101, v102
    v_max3_f32 v10, v10, v103, v104
    v_max3_f32 v10, v10, v105, v106
    v_max_f32 v10, v10, v107
    v_sub_f32 v108, v8, v10
    v_exp_f32 v108, v108
    v_mov_b32 v144, v10
    v_mul_f32 v9, v9, v108
    ds_write_b32 v60, v9 offset:10624
    v_add_f32_dpp v224, v192, v192 row_ror:8 row_mask:0xf bank_mask:0x3
    v_add_f32_dpp v224, v208, v208 row_ror:8 row_mask:0xf bank_mask:0xc
    v_add_f32_dpp v225, v196, v196 row_ror:8 row_mask:0xf bank_mask:0x3
    v_add_f32_dpp v225, v212, v212 row_ror:8 row_mask:0xf bank_mask:0xc
    v_add_f32_dpp v226, v200, v200 row_ror:8 row_mask:0xf bank_mask:0x3
    v_add_f32_dpp v226, v216, v216 row_ror:8 row_mask:0xf bank_mask:0xc
    v_add_f32_dpp v227, v204, v204 row_ror:8 row_mask:0xf bank_mask:0x3
    v_add_f32_dpp v227, v220, v220 row_ror:8 row_mask:0xf bank_mask:0xc
    v_pk_mul_f32 v[224:225], v[224:225], v[108:109] op_sel_hi:[1,0]
    v_pk_mul_f32 v[226:227], v[226:227], v[108:109] op_sel_hi:[1,0]
    ds_write_b128 v11, v[224:227] offset:13312
    v_add_f32_dpp v228, v193, v193 row_ror:8 row_mask:0xf bank_mask:0x3
    v_add_f32_dpp v228, v209, v209 row_ror:8 row_mask:0xf bank_mask:0xc
    v_add_f32_dpp v229, v197, v197 row_ror:8 row_mask:0xf bank_mask:0x3
    v_add_f32_dpp v229, v213, v213 row_ror:8 row_mask:0xf bank_mask:0xc
    v_add_f32_dpp v230, v201, v201 row_ror:8 row_mask:0xf bank_mask:0x3
    v_add_f32_dpp v230, v217, v217 row_ror:8 row_mask:0xf bank_mask:0xc
    v_add_f32_dpp v231, v205, v205 row_ror:8 row_mask:0xf bank_mask:0x3
    v_add_f32_dpp v231, v221, v221 row_ror:8 row_mask:0xf bank_mask:0xc
    v_pk_mul_f32 v[228:229], v[228:229], v[108:109] op_sel_hi:[1,0]
    v_pk_mul_f32 v[230:231], v[230:231], v[108:109] op_sel_hi:[1,0]
    ds_write_b128 v11, v[228:231] offset:13344
    v_add_f32_dpp v232, v194, v194 row_ror:8 row_mask:0xf bank_mask:0x3
    v_add_f32_dpp v232, v210, v210 row_ror:8 row_mask:0xf bank_mask:0xc
    v_add_f32_dpp v233, v198, v198 row_ror:8 row_mask:0xf bank_mask:0x3
    v_add_f32_dpp v233, v214, v214 row_ror:8 row_mask:0xf bank_mask:0xc
    v_add_f32_dpp v234, v202, v202 row_ror:8 row_mask:0xf bank_mask:0x3
    v_add_f32_dpp v234, v218, v218 row_ror:8 row_mask:0xf bank_mask:0xc
    v_add_f32_dpp v235, v206, v206 row_ror:8 row_mask:0xf bank_mask:0x3
    v_add_f32_dpp v235, v222, v222 row_ror:8 row_mask:0xf bank_mask:0xc
    v_pk_mul_f32 v[232:233], v[232:233], v[108:109] op_sel_hi:[1,0]
    v_pk_mul_f32 v[234:235], v[234:235], v[108:109] op_sel_hi:[1,0]
    ds_write_b128 v11, v[232:235] offset:13376
    v_add_f32_dpp v236, v195, v195 row_ror:8 row_mask:0xf bank_mask:0x3
    v_add_f32_dpp v236, v211, v211 row_ror:8 row_mask:0xf bank_mask:0xc
    v_add_f32_dpp v237, v199, v199 row_ror:8 row_mask:0xf bank_mask:0x3
    v_add_f32_dpp v237, v215, v215 row_ror:8 row_mask:0xf bank_mask:0xc
    v_add_f32_dpp v238, v203, v203 row_ror:8 row_mask:0xf bank_mask:0x3
    v_add_f32_dpp v238, v219, v219 row_ror:8 row_mask:0xf bank_mask:0xc
    v_add_f32_dpp v239, v207, v207 row_ror:8 row_mask:0xf bank_mask:0x3
    v_add_f32_dpp v239, v223, v223 row_ror:8 row_mask:0xf bank_mask:0xc
    v_pk_mul_f32 v[236:237], v[236:237], v[108:109] op_sel_hi:[1,0]
    v_pk_mul_f32 v[238:239], v[238:239], v[108:109] op_sel_hi:[1,0]
    ds_write_b128 v11, v[236:239] offset:13408
    s_mov_b64 exec, 1
    ds_add_rtn_u32 v59, v56, v116 offset:10980
    s_mov_b64 exec, -1
    s_waitcnt lgkmcnt(0)
    s_barrier
    ds_read_b128 v[128:131], v115 offset:13312
    ds_read_b128 v[132:135], v115 offset:17664
    ds_read_b128 v[136:139], v115 offset:22016
    ds_read_b128 v[140:143], v115 offset:26368
    ds_read_b128 v[100:103], v117 offset:10624
    ds_read_b128 v[104:107], v117 offset:10640
    v_readfirstlane_b32 s64, v59
    s_cmp_eq_u32 s64, 0
    s_cselect_b32 s80, 1, 0
    s_waitcnt lgkmcnt(4)
    v_pk_add_f32 v[128:129], v[128:129], v[132:133]
    v_pk_add_f32 v[130:131], v[130:131], v[134:135]
    s_waitcnt lgkmcnt(2)
    v_pk_add_f32 v[136:137], v[136:137], v[140:141]
    v_pk_add_f32 v[138:139], v[138:139], v[142:143]
    v_pk_add_f32 v[128:129], v[128:129], v[136:137]
    v_pk_add_f32 v[130:131], v[130:131], v[138:139]
    v_mov_b32 v132, v128
    v_mov_b32 v133, v129
    v_mov_b32 v134, v130
    v_mov_b32 v135, v131
    s_nop 1
    v_permlane32_swap_b32 v128, v132
    v_permlane32_swap_b32 v129, v133
    v_permlane32_swap_b32 v130, v134
    v_permlane32_swap_b32 v131, v135
    s_waitcnt lgkmcnt(0)
    v_pk_add_f32 v[128:129], v[128:129], v[132:133]
    v_pk_add_f32 v[130:131], v[130:131], v[134:135]
    v_pk_add_f32 v[100:101], v[100:101], v[102:103]
    v_pk_add_f32 v[104:105], v[104:105], v[106:107]
    v_bfi_b32 v128, s77, v128, v12
    v_bfi_b32 v129, s77, v129, v13
    v_bfi_b32 v130, s77, v130, v14
    v_bfi_b32 v131, s77, v131, v15
    v_pk_add_f32 v[100:101], v[100:101], v[104:105]
    v_add_f32 v145, v100, v101
    s_mov_b64 exec, 0xffffffff
    buffer_store_dwordx4 v[128:131], v119, s[12:15], s67 offen sc1
    s_mov_b64 exec, s[94:95]
    buffer_store_dwordx4 v[144:147], v118, s[12:15], s66 offen sc1
    s_mov_b64 exec, -1
    s_barrier
    buffer_load_dwordx4 v[16:19], v2, s[88:91], s62 offen offset:0 nt
    buffer_load_dwordx4 v[20:23], v2, s[88:91], s62 offen offset:2048 nt
    buffer_load_dwordx4 v[24:27], v2, s[88:91], s63 offen offset:0 nt
    buffer_load_dwordx4 v[28:31], v2, s[88:91], s63 offen offset:2048 nt
    s_waitcnt vmcnt(3)
    buffer_load_dwordx4 v[32:35], v2, s[84:87], s60 offen offset:0 nt
    s_waitcnt vmcnt(3)
    buffer_load_dwordx4 v[36:39], v2, s[84:87], s60 offen offset:2048 nt
    s_waitcnt vmcnt(3)
    buffer_load_dwordx4 v[40:43], v2, s[84:87], s61 offen offset:0 nt
    s_waitcnt vmcnt(3)
    buffer_load_dwordx4 v[44:47], v2, s[84:87], s61 offen offset:2048 nt
    s_waitcnt vmcnt(4)
    v_lshlrev_b32 v110, 4, v1
    v_lshrrev_b32 v111, 2, v1
    v_lshlrev_b32 v111, 4, v111
    s_lshl_b32 s66, s2, 12
    s_add_u32 s66, s66, 1048576
    s_lshr_b32 s67, s2, 3
    s_lshl_b32 s67, s67, 10
    s_add_u32 s67, s67, 262144
    s_cmp_eq_u32 s80, 0
    s_cbranch_scc1 L_NP33
    buffer_load_dwordx4 v[160:163], v110, s[12:15], s66 offen offset:0 sc1
    buffer_load_dwordx3 v[176:178], v111, s[12:15], s67 offen offset:0 sc1
    buffer_load_dwordx4 v[164:167], v110, s[12:15], s66 offen offset:1024 sc1
    buffer_load_dwordx3 v[180:182], v111, s[12:15], s67 offen offset:256 sc1
    buffer_load_dwordx4 v[168:171], v110, s[12:15], s66 offen offset:2048 sc1
    buffer_load_dwordx3 v[184:186], v111, s[12:15], s67 offen offset:512 sc1
    buffer_load_dwordx4 v[172:175], v110, s[12:15], s66 offen offset:3072 sc1
    buffer_load_dwordx3 v[188:190], v111, s[12:15], s67 offen offset:768 sc1
L_NP33:
    v_mov_b32 v120, 0
    v_mov_b32 v121, 0
    v_mov_b32 v122, 0
    v_mov_b32 v123, 0
    v_mov_b32 v124, 0
    v_mov_b32 v125, 0
    v_mov_b32 v126, 0
    v_mov_b32 v127, 0
    v_and_b32 v56, 0xffff, v62
    v_lshlrev_b32 v59, 16, v62
    v_dot2c_f32_bf16 v120, v16, v56
    v_dot2c_f32_bf16 v121, v16, v59
    v_dot2c_f32_bf16 v122, v17, v56
    v_dot2c_f32_bf16 v123, v17, v59
    v_dot2c_f32_bf16 v124, v18, v56
    v_dot2c_f32_bf16 v125, v18, v59
    v_dot2c_f32_bf16 v126, v19, v56
    v_dot2c_f32_bf16 v127, v19, v59
    v_lshrrev_b32 v56, 16, v62
    v_and_b32 v59, 0xffff0000, v62
    v_dot2c_f32_bf16 v120, v20, v56
    v_dot2c_f32_bf16 v121, v20, v59
    v_dot2c_f32_bf16 v122, v21, v56
    v_dot2c_f32_bf16 v123, v21, v59
    v_dot2c_f32_bf16 v124, v22, v56
    v_dot2c_f32_bf16 v125, v22, v59
    v_dot2c_f32_bf16 v126, v23, v56
    v_dot2c_f32_bf16 v127, v23, v59
    v_and_b32 v56, 0xffff, v63
    v_lshlrev_b32 v59, 16, v63
    v_dot2c_f32_bf16 v120, v24, v56
    v_dot2c_f32_bf16 v121, v24, v59
    v_dot2c_f32_bf16 v122, v25, v56
    v_dot2c_f32_bf16 v123, v25, v59
    v_dot2c_f32_bf16 v124, v26, v56
    v_dot2c_f32_bf16 v125, v26, v59
    v_dot2c_f32_bf16 v126, v27, v56
    v_dot2c_f32_bf16 v127, v27, v59
    v_lshrrev_b32 v56, 16, v63
    v_and_b32 v59, 0xffff0000, v63
    v_dot2c_f32_bf16 v120, v28, v56
    v_dot2c_f32_bf16 v121, v28, v59
    v_dot2c_f32_bf16 v122, v29, v56
    v_dot2c_f32_bf16 v123, v29, v59
    v_dot2c_f32_bf16 v124, v30, v56
    v_dot2c_f32_bf16 v125, v30, v59
    v_dot2c_f32_bf16 v126, v31, v56
    v_dot2c_f32_bf16 v127, v31, v59
    s_nop 1
    v_permlane32_swap_b32 v120, v121
    v_permlane32_swap_b32 v122, v123
    v_permlane32_swap_b32 v124, v125
    v_permlane32_swap_b32 v126, v127
    v_add_f32 v120, v120, v121
    v_add_f32 v122, v122, v123
    v_add_f32 v124, v124, v125
    v_add_f32 v126, v126, v127
    s_nop 1
    v_permlane16_swap_b32 v120, v122
    v_permlane16_swap_b32 v124, v126
    v_add_f32 v120, v120, v122
    v_add_f32 v124, v124, v126
    v_and_b32 v56, 1, v3
    v_lshlrev_b32 v56, 1, v56
    v_lshrrev_b32 v59, 1, v3
    v_or_b32 v56, v56, v59
    v_lshl_add_u32 v56, v4, 3, v56
    v_lshlrev_b32 v56, 2, v56
    s_lshl_b32 s64, s3, 9
    v_add_u32 v56, s64, v56
    v_add_u32 v56, 4096, v56
    ds_write2_b32 v56, v120, v124 offset0:0 offset1:4
    v_mov_b32 v56, 0
    v_mov_b32 v59, 1
    s_waitcnt lgkmcnt(0)
    s_mov_b64 exec, 1
    ds_add_rtn_u32 v59, v56, v59 offset:10984
    s_mov_b64 exec, -1
    s_waitcnt lgkmcnt(0)
    v_readfirstlane_b32 s64, v59
    s_cmp_lg_u32 s64, 7
    s_cbranch_scc1 L_ND34
    v_and_b32 v56, 31, v1
    v_lshlrev_b32 v56, 4, v56
    ds_read_b128 v[64:67], v56 offset:4096
    ds_read_b128 v[68:71], v56 offset:4608
    ds_read_b128 v[72:75], v56 offset:5120
    ds_read_b128 v[76:79], v56 offset:5632
    ds_read_b128 v[80:83], v56 offset:6144
    ds_read_b128 v[84:87], v56 offset:6656
    ds_read_b128 v[88:91], v56 offset:7168
    ds_read_b128 v[92:95], v56 offset:7680
    v_bfe_u32 v56, v1, 3, 2
    v_mul_u32_u24 v56, 36864, v56
    v_and_b32 v59, 7, v1
    v_lshl_add_u32 v56, v59, 4, v56
    s_and_b32 s64, s98, 7
    s_mul_i32 s64, s64, 147456
    s_lshr_b32 s65, s98, 3
    s_lshl_b32 s65, s65, 7
    s_add_u32 s64, s64, s65
    s_add_u32 s64, s64, 2129920
    s_waitcnt lgkmcnt(0)
    v_pk_add_f32 v[64:65], v[64:65], v[68:69]
    v_pk_add_f32 v[66:67], v[66:67], v[70:71]
    v_pk_add_f32 v[72:73], v[72:73], v[76:77]
    v_pk_add_f32 v[74:75], v[74:75], v[78:79]
    v_pk_add_f32 v[80:81], v[80:81], v[84:85]
    v_pk_add_f32 v[82:83], v[82:83], v[86:87]
    v_pk_add_f32 v[88:89], v[88:89], v[92:93]
    v_pk_add_f32 v[90:91], v[90:91], v[94:95]
    v_pk_add_f32 v[64:65], v[64:65], v[72:73]
    v_pk_add_f32 v[66:67], v[66:67], v[74:75]
    v_pk_add_f32 v[80:81], v[80:81], v[88:89]
    v_pk_add_f32 v[82:83], v[82:83], v[90:91]
    v_pk_add_f32 v[64:65], v[64:65], v[80:81]
    v_pk_add_f32 v[66:67], v[66:67], v[82:83]
    v_bfi_b32 v64, s77, v64, v12
    v_bfi_b32 v65, s77, v65, v13
    v_bfi_b32 v66, s77, v66, v14
    v_bfi_b32 v67, s77, v67, v15
    s_mov_b64 exec, 0xffffffff
    buffer_store_dwordx4 v[64:67], v56, s[12:15], s64 offen sc1
    s_mov_b64 exec, -1
L_ND34:
    s_cmp_eq_u32 s80, 0
    s_cbranch_scc1 L_NP35
    s_mov_b64 s[74:75], -1
    s_mov_b32 s76, 0
L_PL36:
    s_waitcnt vmcnt(0)
    v_xor_b32 v128, v12, v160
    v_xor_b32 v129, v13, v161
    v_xor_b32 v130, v14, v162
    v_xor_b32 v131, v15, v163
    v_xor_b32 v132, v12, v164
    v_xor_b32 v133, v13, v165
    v_xor_b32 v134, v14, v166
    v_xor_b32 v135, v15, v167
    v_xor_b32 v136, v12, v168
    v_xor_b32 v137, v13, v169
    v_xor_b32 v138, v14, v170
    v_xor_b32 v139, v15, v171
    v_xor_b32 v140, v12, v172
    v_xor_b32 v141, v13, v173
    v_xor_b32 v142, v14, v174
    v_xor_b32 v143, v15, v175
    v_or3_b32 v56, v128, v129, v130
    v_or_b32 v56, v56, v131
    v_or3_b32 v56, v56, v132, v133
    v_or3_b32 v56, v56, v134, v135
    v_or3_b32 v56, v56, v136, v137
    v_or3_b32 v56, v56, v138, v139
    v_or3_b32 v56, v56, v140, v141
    v_or3_b32 v56, v56, v142, v143
    v_and_b32 v56, 0xff, v56
    v_pk_mov_b32 v[144:145], v[176:177], v[176:177] op_sel:[0,1]
    v_xor_b32 v147, s47, v178
    v_pk_mov_b32 v[148:149], v[180:181], v[180:181] op_sel:[0,1]
    v_xor_b32 v151, s47, v182
    v_pk_mov_b32 v[152:153], v[184:185], v[184:185] op_sel:[0,1]
    v_xor_b32 v155, s47, v186
    v_pk_mov_b32 v[156:157], v[188:189], v[188:189] op_sel:[0,1]
    v_xor_b32 v159, s47, v190
    v_or3_b32 v56, v56, v147, v151
    v_or3_b32 v56, v56, v155, v159
    v_cmp_ne_u32 vcc, 0, v56
    s_mov_b64 exec, -1
    s_cbranch_vccz L_PD37
    s_add_u32 s76, s76, 1
    s_cmp_lt_u32 s76, 200000
    s_cbranch_scc0 L_PD37
    s_sleep 1
    s_mov_b64 exec, vcc
    buffer_load_dwordx4 v[160:163], v110, s[12:15], s66 offen offset:0 sc1
    buffer_load_dwordx3 v[176:178], v111, s[12:15], s67 offen offset:0 sc1
    buffer_load_dwordx4 v[164:167], v110, s[12:15], s66 offen offset:1024 sc1
    buffer_load_dwordx3 v[180:182], v111, s[12:15], s67 offen offset:256 sc1
    buffer_load_dwordx4 v[168:171], v110, s[12:15], s66 offen offset:2048 sc1
    buffer_load_dwordx3 v[184:186], v111, s[12:15], s67 offen offset:512 sc1
    buffer_load_dwordx4 v[172:175], v110, s[12:15], s66 offen offset:3072 sc1
    buffer_load_dwordx3 v[188:190], v111, s[12:15], s67 offen offset:768 sc1
    s_branch L_PL36
L_PD37:
    v_max3_f32 v100, v144, v148, v152
    v_max_f32 v100, v100, v156
    s_nop 1
    v_max_f32_dpp v100, v100, v100 row_ror:4 row_mask:0xf bank_mask:0xf
    s_nop 1
    v_max_f32_dpp v100, v100, v100 row_ror:8 row_mask:0xf bank_mask:0xf
    v_mov_b32 v56, v100
    s_nop 1
    v_permlane16_swap_b32 v100, v56
    v_max_f32 v100, v100, v56
    v_mov_b32 v56, v100
    s_nop 1
    v_permlane32_swap_b32 v100, v56
    v_max_f32 v100, v100, v56
    v_sub_f32 v144, v144, v100
    v_sub_f32 v148, v148, v100
    v_sub_f32 v152, v152, v100
    v_sub_f32 v156, v156, v100
    v_exp_f32 v144, v144
    v_exp_f32 v148, v148
    v_exp_f32 v152, v152
    v_exp_f32 v156, v156
    s_nop 0
    v_mul_f32 v104, v144, v145
    v_mul_f32 v100, v144, v128
    v_mul_f32 v101, v144, v129
    v_mul_f32 v102, v144, v130
    v_mul_f32 v103, v144, v131
    v_fmac_f32 v104, v148, v149
    v_fmac_f32 v100, v148, v132
    v_fmac_f32 v101, v148, v133
    v_fmac_f32 v102, v148, v134
    v_fmac_f32 v103, v148, v135
    v_fmac_f32 v104, v152, v153
    v_fmac_f32 v100, v152, v136
    v_fmac_f32 v101, v152, v137
    v_fmac_f32 v102, v152, v138
    v_fmac_f32 v103, v152, v139
    v_fmac_f32 v104, v156, v157
    v_fmac_f32 v100, v156, v140
    v_fmac_f32 v101, v156, v141
    v_fmac_f32 v102, v156, v142
    v_fmac_f32 v103, v156, v143
    s_nop 1
    v_add_f32_dpp v100, v100, v100 row_ror:4 row_mask:0xf bank_mask:0xf
    v_add_f32_dpp v101, v101, v101 row_ror:4 row_mask:0xf bank_mask:0xf
    v_add_f32_dpp v102, v102, v102 row_ror:4 row_mask:0xf bank_mask:0xf
    v_add_f32_dpp v103, v103, v103 row_ror:4 row_mask:0xf bank_mask:0xf
    v_add_f32_dpp v104, v104, v104 row_ror:4 row_mask:0xf bank_mask:0xf
    s_nop 1
    v_add_f32_dpp v100, v100, v100 row_ror:8 row_mask:0xf bank_mask:0xf
    v_add_f32_dpp v101, v101, v101 row_ror:8 row_mask:0xf bank_mask:0xf
    v_add_f32_dpp v102, v102, v102 row_ror:8 row_mask:0xf bank_mask:0xf
    v_add_f32_dpp v103, v103, v103 row_ror:8 row_mask:0xf bank_mask:0xf
    v_add_f32_dpp v104, v104, v104 row_ror:8 row_mask:0xf bank_mask:0xf
    v_mov_b32 v105, v100
    v_mov_b32 v106, v101
    v_mov_b32 v107, v102
    v_mov_b32 v108, v103
    v_mov_b32 v109, v104
    s_nop 1
    v_permlane16_swap_b32 v100, v105
    v_permlane16_swap_b32 v101, v106
    v_permlane16_swap_b32 v102, v107
    v_permlane16_swap_b32 v103, v108
    v_permlane16_swap_b32 v104, v109
    v_add_f32 v100, v100, v105
    v_add_f32 v101, v101, v106
    v_add_f32 v102, v102, v107
    v_add_f32 v103, v103, v108
    v_add_f32 v104, v104, v109
    v_mov_b32 v105, v100
    v_mov_b32 v106, v101
    v_mov_b32 v107, v102
    v_mov_b32 v108, v103
    v_mov_b32 v109, v104
    s_nop 1
    v_permlane32_swap_b32 v100, v105
    v_permlane32_swap_b32 v101, v106
    v_permlane32_swap_b32 v102, v107
    v_permlane32_swap_b32 v103, v108
    v_permlane32_swap_b32 v104, v109
    v_add_f32 v100, v100, v105
    v_add_f32 v101, v101, v106
    v_add_f32 v102, v102, v107
    v_add_f32 v103, v103, v108
    v_add_f32 v104, v104, v109
    v_rcp_f32 v104, v104
    v_lshlrev_b32 v56, 4, v1
    v_mov_b32 v106, 1
    v_mov_b32 v107, 1
    v_mul_f32 v100, v100, v104
    v_mul_f32 v101, v101, v104
    v_mul_f32 v102, v102, v104
    v_mul_f32 v103, v103, v104
    v_cvt_pk_bf16_f32 v104, v100, v101
    v_cvt_pk_bf16_f32 v105, v102, v103
    s_mov_b64 exec, 0xf
    ds_write_b128 v56, v[104:107] offset:10880
    s_mov_b64 exec, -1
L_NP35:
    v_lshlrev_b32 v56, 4, v3
    v_lshrrev_b32 v114, 2, v4
    v_mul_u32_u24 v114, 36864, v114
    v_and_b32 v59, 3, v4
    v_lshl_add_u32 v114, v59, 5, v114
    v_lshrrev_b32 v59, 5, v1
    v_lshl_add_u32 v114, v59, 4, v114
    s_mul_i32 s64, s3, 147456
    s_lshl_b32 s65, s2, 7
    s_add_u32 s64, s64, s65
    s_add_u32 s64, s64, 2097152
    s_mov_b32 s94, 0xffff
    s_mov_b32 s95, 0xffff
    s_mov_b32 s76, 0
L_OL38:
    ds_read_b128 v[104:107], v56 offset:10880
    s_waitcnt lgkmcnt(0)
    v_cmp_ne_u32 vcc, 1, v106
    s_cbranch_vccz L_OD39
    s_sleep 1
    s_add_u32 s76, s76, 1
    s_cmp_lt_u32 s76, 4000000
    s_cbranch_scc1 L_OL38
L_OD39:
    s_cmp_lg_u32 s80, 0
    s_cbranch_scc1 L_SW40
    s_waitcnt vmcnt(0)
L_SW40:
    v_mov_b32 v120, 0
    v_mov_b32 v121, 0
    v_mov_b32 v122, 0
    v_mov_b32 v123, 0
    v_mov_b32 v124, 0
    v_mov_b32 v125, 0
    v_mov_b32 v126, 0
    v_mov_b32 v127, 0
    v_and_b32 v56, 0xffff, v104
    v_lshlrev_b32 v59, 16, v104
    v_dot2c_f32_bf16 v120, v32, v56
    v_dot2c_f32_bf16 v121, v32, v59
    v_dot2c_f32_bf16 v122, v33, v56
    v_dot2c_f32_bf16 v123, v33, v59
    v_dot2c_f32_bf16 v124, v34, v56
    v_dot2c_f32_bf16 v125, v34, v59
    v_dot2c_f32_bf16 v126, v35, v56
    v_dot2c_f32_bf16 v127, v35, v59
    v_lshrrev_b32 v56, 16, v104
    v_and_b32 v59, 0xffff0000, v104
    v_dot2c_f32_bf16 v120, v36, v56
    v_dot2c_f32_bf16 v121, v36, v59
    v_dot2c_f32_bf16 v122, v37, v56
    v_dot2c_f32_bf16 v123, v37, v59
    v_dot2c_f32_bf16 v124, v38, v56
    v_dot2c_f32_bf16 v125, v38, v59
    v_dot2c_f32_bf16 v126, v39, v56
    v_dot2c_f32_bf16 v127, v39, v59
    v_and_b32 v56, 0xffff, v105
    v_lshlrev_b32 v59, 16, v105
    v_dot2c_f32_bf16 v120, v40, v56
    v_dot2c_f32_bf16 v121, v40, v59
    v_dot2c_f32_bf16 v122, v41, v56
    v_dot2c_f32_bf16 v123, v41, v59
    v_dot2c_f32_bf16 v124, v42, v56
    v_dot2c_f32_bf16 v125, v42, v59
    v_dot2c_f32_bf16 v126, v43, v56
    v_dot2c_f32_bf16 v127, v43, v59
    v_lshrrev_b32 v56, 16, v105
    v_and_b32 v59, 0xffff0000, v105
    v_dot2c_f32_bf16 v120, v44, v56
    v_dot2c_f32_bf16 v121, v44, v59
    v_dot2c_f32_bf16 v122, v45, v56
    v_dot2c_f32_bf16 v123, v45, v59
    v_dot2c_f32_bf16 v124, v46, v56
    v_dot2c_f32_bf16 v125, v46, v59
    v_dot2c_f32_bf16 v126, v47, v56
    v_dot2c_f32_bf16 v127, v47, v59
    s_nop 1
    v_permlane32_swap_b32 v120, v124
    v_permlane32_swap_b32 v121, v125
    v_permlane32_swap_b32 v122, v126
    v_permlane32_swap_b32 v123, v127
    v_add_f32 v120, v120, v124
    v_add_f32 v121, v121, v125
    v_add_f32 v122, v122, v126
    v_add_f32 v123, v123, v127
    v_mov_b32 v124, v120
    v_mov_b32 v125, v121
    v_mov_b32 v126, v122
    v_mov_b32 v127, v123
    s_nop 1
    v_permlane16_swap_b32 v120, v124
    v_permlane16_swap_b32 v121, v125
    v_permlane16_swap_b32 v122, v126
    v_permlane16_swap_b32 v123, v127
    v_add_f32 v120, v120, v124
    v_add_f32 v121, v121, v125
    v_add_f32 v122, v122, v126
    v_add_f32 v123, v123, v127
    v_bfi_b32 v120, s77, v120, v12
    v_bfi_b32 v121, s77, v121, v13
    v_bfi_b32 v122, s77, v122, v14
    v_bfi_b32 v123, s77, v123, v15
    s_mov_b64 exec, s[94:95]
    buffer_store_dwordx4 v[120:123], v114, s[12:15], s64 offen sc1
    s_mov_b64 exec, -1
    s_branch L_FIN_END
L_LIGHT:
    buffer_load_dwordx2 v[96:97], v11, s[16:19], s59 offen
    buffer_load_dwordx4 v[64:67], v60, s[24:27], s58 offen nt
    s_add_u32 s58, s58, 7168
    buffer_load_dwordx4 v[68:71], v60, s[24:27], s58 offen nt
    s_add_u32 s58, s58, 7168
    s_waitcnt lgkmcnt(0)
    s_barrier
    s_waitcnt vmcnt(3)
    v_mov_b32 v48, 0
    v_mov_b32 v49, 0
    v_mov_b32 v50, 0
    v_mov_b32 v51, 0
    v_mov_b32 v52, 0
    v_mov_b32 v53, 0
    v_mov_b32 v54, 0
    v_mov_b32 v55, 0
    v_and_b32 v56, 0xffff, v8
    v_lshlrev_b32 v59, 16, v8
    v_dot2c_f32_bf16 v48, v16, v56
    v_dot2c_f32_bf16 v49, v16, v59
    v_dot2c_f32_bf16 v50, v17, v56
    v_dot2c_f32_bf16 v51, v17, v59
    v_dot2c_f32_bf16 v52, v18, v56
    v_dot2c_f32_bf16 v53, v18, v59
    v_dot2c_f32_bf16 v54, v19, v56
    v_dot2c_f32_bf16 v55, v19, v59
    v_lshrrev_b32 v56, 16, v8
    v_and_b32 v59, 0xffff0000, v8
    v_dot2c_f32_bf16 v48, v20, v56
    v_dot2c_f32_bf16 v49, v20, v59
    v_dot2c_f32_bf16 v50, v21, v56
    v_dot2c_f32_bf16 v51, v21, v59
    v_dot2c_f32_bf16 v52, v22, v56
    v_dot2c_f32_bf16 v53, v22, v59
    v_dot2c_f32_bf16 v54, v23, v56
    v_dot2c_f32_bf16 v55, v23, v59
    s_waitcnt vmcnt(2)
    buffer_load_dwordx4 v[72:75], v60, s[24:27], s58 offen nt
    s_add_u32 s58, s58, 7168
    v_and_b32 v56, 0xffff, v9
    v_lshlrev_b32 v59, 16, v9
    v_dot2c_f32_bf16 v48, v24, v56
    v_dot2c_f32_bf16 v49, v24, v59
    v_dot2c_f32_bf16 v50, v25, v56
    v_dot2c_f32_bf16 v51, v25, v59
    v_dot2c_f32_bf16 v52, v26, v56
    v_dot2c_f32_bf16 v53, v26, v59
    v_dot2c_f32_bf16 v54, v27, v56
    v_dot2c_f32_bf16 v55, v27, v59
    v_lshrrev_b32 v56, 16, v9
    v_and_b32 v59, 0xffff0000, v9
    v_dot2c_f32_bf16 v48, v28, v56
    v_dot2c_f32_bf16 v49, v28, v59
    v_dot2c_f32_bf16 v50, v29, v56
    v_dot2c_f32_bf16 v51, v29, v59
    v_dot2c_f32_bf16 v52, v30, v56
    v_dot2c_f32_bf16 v53, v30, v59
    v_dot2c_f32_bf16 v54, v31, v56
    v_dot2c_f32_bf16 v55, v31, v59
    s_waitcnt vmcnt(2)
    buffer_load_dwordx4 v[76:79], v60, s[24:27], s58 offen nt
    s_nop 1
    v_permlane32_swap_b32 v48, v49
    v_permlane32_swap_b32 v50, v51
    v_permlane32_swap_b32 v52, v53
    v_permlane32_swap_b32 v54, v55
    v_add_f32 v48, v48, v49
    v_add_f32 v50, v50, v51
    v_add_f32 v52, v52, v53
    v_add_f32 v54, v54, v55
    s_nop 1
    v_permlane16_swap_b32 v48, v50
    v_permlane16_swap_b32 v52, v54
    v_add_f32 v48, v48, v50
    v_add_f32 v52, v52, v54
    s_nop 1
    v_add_f32_dpp v48, v48, v48 row_ror:8 row_mask:0xf bank_mask:0xf
    v_add_f32_dpp v52, v52, v52 row_ror:8 row_mask:0xf bank_mask:0xf
    v_and_b32 v56, 8, v1
    v_cmp_ne_u32 vcc, 0, v56
    s_nop 1
    v_cndmask_b32 v48, v48, v52, vcc
    ds_write_b32 v7, v48 offset:0
    v_mov_b32 v56, 0
    v_mov_b32 v59, 1
    s_waitcnt lgkmcnt(0)
    s_mov_b64 exec, 1
    ds_add_u32 v56, v59 offset:10960
    s_mov_b64 exec, -1
    s_waitcnt vmcnt(2)
    buffer_load_dwordx4 v[128:131], v5, s[4:7], s48 offen offset:0 nt
    s_waitcnt vmcnt(2)
    buffer_load_dwordx4 v[132:135], v5, s[4:7], s48 offen offset:128 nt
    s_waitcnt vmcnt(2)
    buffer_load_dwordx4 v[136:139], v5, s[4:7], s48 offen offset:512 nt
    s_waitcnt vmcnt(3)
    v_mov_b32 v48, 0
    v_mov_b32 v49, 0
    v_mov_b32 v50, 0
    v_mov_b32 v51, 0
    v_mov_b32 v52, 0
    v_mov_b32 v53, 0
    v_mov_b32 v54, 0
    v_mov_b32 v55, 0
    v_and_b32 v56, 0xffff, v96
    v_lshlrev_b32 v59, 16, v96
    v_dot2c_f32_bf16 v48, v64, v56
    v_dot2c_f32_bf16 v49, v64, v59
    v_dot2c_f32_bf16 v50, v65, v56
    v_dot2c_f32_bf16 v51, v65, v59
    v_dot2c_f32_bf16 v52, v66, v56
    v_dot2c_f32_bf16 v53, v66, v59
    v_dot2c_f32_bf16 v54, v67, v56
    v_dot2c_f32_bf16 v55, v67, v59
    v_lshrrev_b32 v56, 16, v96
    v_and_b32 v59, 0xffff0000, v96
    v_dot2c_f32_bf16 v48, v68, v56
    v_dot2c_f32_bf16 v49, v68, v59
    v_dot2c_f32_bf16 v50, v69, v56
    v_dot2c_f32_bf16 v51, v69, v59
    v_dot2c_f32_bf16 v52, v70, v56
    v_dot2c_f32_bf16 v53, v70, v59
    v_dot2c_f32_bf16 v54, v71, v56
    v_dot2c_f32_bf16 v55, v71, v59
    s_waitcnt vmcnt(2)
    buffer_load_dwordx4 v[140:143], v5, s[4:7], s48 offen offset:640 nt
    v_and_b32 v56, 0xffff, v97
    v_lshlrev_b32 v59, 16, v97
    v_dot2c_f32_bf16 v48, v72, v56
    v_dot2c_f32_bf16 v49, v72, v59
    v_dot2c_f32_bf16 v50, v73, v56
    v_dot2c_f32_bf16 v51, v73, v59
    v_dot2c_f32_bf16 v52, v74, v56
    v_dot2c_f32_bf16 v53, v74, v59
    v_dot2c_f32_bf16 v54, v75, v56
    v_dot2c_f32_bf16 v55, v75, v59
    v_lshrrev_b32 v56, 16, v97
    v_and_b32 v59, 0xffff0000, v97
    v_dot2c_f32_bf16 v48, v76, v56
    v_dot2c_f32_bf16 v49, v76, v59
    v_dot2c_f32_bf16 v50, v77, v56
    v_dot2c_f32_bf16 v51, v77, v59
    v_dot2c_f32_bf16 v52, v78, v56
    v_dot2c_f32_bf16 v53, v78, v59
    v_dot2c_f32_bf16 v54, v79, v56
    v_dot2c_f32_bf16 v55, v79, v59
    s_waitcnt vmcnt(2)
    buffer_load_dwordx4 v[144:147], v5, s[4:7], s49 offen offset:0 nt
    s_nop 1
    v_permlane32_swap_b32 v48, v49
    v_permlane32_swap_b32 v50, v51
    v_permlane32_swap_b32 v52, v53
    v_permlane32_swap_b32 v54, v55
    v_add_f32 v48, v48, v49
    v_add_f32 v50, v50, v51
    v_add_f32 v52, v52, v53
    v_add_f32 v54, v54, v55
    s_nop 1
    v_permlane16_swap_b32 v48, v50
    v_permlane16_swap_b32 v52, v54
    v_add_f32 v48, v48, v50
    v_add_f32 v52, v52, v54
    s_nop 1
    v_add_f32_dpp v48, v48, v48 row_ror:8 row_mask:0xf bank_mask:0xf
    v_add_f32_dpp v52, v52, v52 row_ror:8 row_mask:0xf bank_mask:0xf
    v_and_b32 v56, 8, v1
    v_cmp_ne_u32 vcc, 0, v56
    s_nop 1
    v_cndmask_b32 v48, v48, v52, vcc
    ds_write_b32 v7, v48 offset:2048
    v_mov_b32 v56, 0
    v_mov_b32 v59, 1
    s_waitcnt lgkmcnt(0)
    s_mov_b64 exec, 1
    ds_add_u32 v56, v59 offset:10964
    s_mov_b64 exec, -1
    s_waitcnt vmcnt(2)
    buffer_load_dwordx4 v[148:151], v5, s[4:7], s49 offen offset:128 nt
    s_cmp_lg_u32 s3, 0
    s_cbranch_scc1 L_HS41
    s_cmp_lg_u32 s46, 0
    s_cbranch_scc1 L_HS41
    s_mov_b32 s76, 0
    s_cmp_lg_u32 s47, 0
    s_cbranch_scc1 L_HH42
    s_waitcnt vmcnt(16)
L_HR43:
    v_readfirstlane_b32 s47, v58
    s_cmp_eq_u32 s47, 0
    s_cselect_b32 s47, s96, s47
    s_cmp_lg_u32 s47, 0
    s_cbranch_scc1 L_HG44
    buffer_load_dword v58, off, s[28:31], 0 sc1
    s_branch L_HS41
L_HG44:
    v_mov_b32 v56, 0
    v_mov_b32 v59, s47
    ds_write_b32 v56, v59 offset:10968
L_HH42:
    v_mov_b32 v56, 0
L_HQ45:
    ds_read_b64 v[96:97], v56 offset:10960
    s_waitcnt lgkmcnt(0)
    v_readfirstlane_b32 s64, v96
    v_readfirstlane_b32 s65, v97
    s_add_u32 s64, s64, s65
    s_cmp_eq_u32 s64, 16
    s_cbranch_scc0 L_HS41
    v_and_b32 v56, 1, v3
    v_lshlrev_b32 v59, 11, v56
    v_lshl_add_u32 v59, v4, 4, v59
    ds_read_b128 v[64:67], v59 offset:0
    ds_read_b128 v[68:71], v59 offset:256
    ds_read_b128 v[72:75], v59 offset:512
    ds_read_b128 v[76:79], v59 offset:768
    ds_read_b128 v[80:83], v59 offset:1024
    ds_read_b128 v[84:87], v59 offset:1280
    ds_read_b128 v[88:91], v59 offset:1536
    ds_read_b128 v[92:95], v59 offset:1792
    v_mov_b32 v15, s47
    v_and_b32 v12, 0xff, v15
    v_bfe_u32 v13, v15, 8, 8
    v_bfe_u32 v14, v15, 16, 8
    v_lshrrev_b32 v15, 24, v15
    v_mov_b32 v59, s92
    v_mov_b32 v96, s93
    v_cmp_ne_u32 vcc, 0, v56
    s_nop 1
    v_cndmask_b32 v59, v59, v96, vcc
    v_lshl_add_u32 v59, v4, 4, v59
    s_waitcnt lgkmcnt(0)
    v_pk_add_f32 v[64:65], v[64:65], v[68:69]
    v_pk_add_f32 v[66:67], v[66:67], v[70:71]
    v_pk_add_f32 v[72:73], v[72:73], v[76:77]
    v_pk_add_f32 v[74:75], v[74:75], v[78:79]
    v_pk_add_f32 v[80:81], v[80:81], v[84:85]
    v_pk_add_f32 v[82:83], v[82:83], v[86:87]
    v_pk_add_f32 v[88:89], v[88:89], v[92:93]
    v_pk_add_f32 v[90:91], v[90:91], v[94:95]
    v_pk_add_f32 v[64:65], v[64:65], v[72:73]
    v_pk_add_f32 v[66:67], v[66:67], v[74:75]
    v_pk_add_f32 v[80:81], v[80:81], v[88:89]
    v_pk_add_f32 v[82:83], v[82:83], v[90:91]
    v_pk_add_f32 v[64:65], v[64:65], v[80:81]
    v_pk_add_f32 v[66:67], v[66:67], v[82:83]
    v_bfi_b32 v64, s77, v64, v12
    v_bfi_b32 v65, s77, v65, v13
    v_bfi_b32 v66, s77, v66, v14
    v_bfi_b32 v67, s77, v67, v15
    s_mov_b64 exec, 0xffffffff
    buffer_store_dwordx4 v[64:67], v59, s[12:15], 0 offen sc1
    s_mov_b64 exec, -1
    s_mov_b32 s46, 1
L_HS41:
    s_waitcnt vmcnt(2)
    buffer_load_dwordx4 v[152:155], v5, s[4:7], s49 offen offset:512 nt
    s_waitcnt vmcnt(2)
    buffer_load_dwordx4 v[156:159], v5, s[4:7], s49 offen offset:640 nt
    s_cmp_lg_u32 s3, 0
    s_cbranch_scc1 L_HS46
    s_cmp_lg_u32 s46, 0
    s_cbranch_scc1 L_HS46
    s_mov_b32 s76, 0
    s_cmp_lg_u32 s47, 0
    s_cbranch_scc1 L_HH47
    s_waitcnt vmcnt(2)
L_HR48:
    v_readfirstlane_b32 s47, v58
    s_cmp_eq_u32 s47, 0
    s_cselect_b32 s47, s96, s47
    s_cmp_lg_u32 s47, 0
    s_cbranch_scc1 L_HG49
    buffer_load_dword v58, off, s[28:31], 0 sc1
    s_branch L_HS46
L_HG49:
    v_mov_b32 v56, 0
    v_mov_b32 v59, s47
    ds_write_b32 v56, v59 offset:10968
L_HH47:
    v_mov_b32 v56, 0
L_HQ50:
    ds_read_b64 v[96:97], v56 offset:10960
    s_waitcnt lgkmcnt(0)
    v_readfirstlane_b32 s64, v96
    v_readfirstlane_b32 s65, v97
    s_add_u32 s64, s64, s65
    s_cmp_eq_u32 s64, 16
    s_cbranch_scc0 L_HS46
    v_and_b32 v56, 1, v3
    v_lshlrev_b32 v59, 11, v56
    v_lshl_add_u32 v59, v4, 4, v59
    ds_read_b128 v[64:67], v59 offset:0
    ds_read_b128 v[68:71], v59 offset:256
    ds_read_b128 v[72:75], v59 offset:512
    ds_read_b128 v[76:79], v59 offset:768
    ds_read_b128 v[80:83], v59 offset:1024
    ds_read_b128 v[84:87], v59 offset:1280
    ds_read_b128 v[88:91], v59 offset:1536
    ds_read_b128 v[92:95], v59 offset:1792
    v_mov_b32 v15, s47
    v_and_b32 v12, 0xff, v15
    v_bfe_u32 v13, v15, 8, 8
    v_bfe_u32 v14, v15, 16, 8
    v_lshrrev_b32 v15, 24, v15
    v_mov_b32 v59, s92
    v_mov_b32 v96, s93
    v_cmp_ne_u32 vcc, 0, v56
    s_nop 1
    v_cndmask_b32 v59, v59, v96, vcc
    v_lshl_add_u32 v59, v4, 4, v59
    s_waitcnt lgkmcnt(0)
    v_pk_add_f32 v[64:65], v[64:65], v[68:69]
    v_pk_add_f32 v[66:67], v[66:67], v[70:71]
    v_pk_add_f32 v[72:73], v[72:73], v[76:77]
    v_pk_add_f32 v[74:75], v[74:75], v[78:79]
    v_pk_add_f32 v[80:81], v[80:81], v[84:85]
    v_pk_add_f32 v[82:83], v[82:83], v[86:87]
    v_pk_add_f32 v[88:89], v[88:89], v[92:93]
    v_pk_add_f32 v[90:91], v[90:91], v[94:95]
    v_pk_add_f32 v[64:65], v[64:65], v[72:73]
    v_pk_add_f32 v[66:67], v[66:67], v[74:75]
    v_pk_add_f32 v[80:81], v[80:81], v[88:89]
    v_pk_add_f32 v[82:83], v[82:83], v[90:91]
    v_pk_add_f32 v[64:65], v[64:65], v[80:81]
    v_pk_add_f32 v[66:67], v[66:67], v[82:83]
    v_bfi_b32 v64, s77, v64, v12
    v_bfi_b32 v65, s77, v65, v13
    v_bfi_b32 v66, s77, v66, v14
    v_bfi_b32 v67, s77, v67, v15
    s_mov_b64 exec, 0xffffffff
    buffer_store_dwordx4 v[64:67], v59, s[12:15], 0 offen sc1
    s_mov_b64 exec, -1
    s_mov_b32 s46, 1
L_HS46:
    s_waitcnt vmcnt(2)
    buffer_load_dwordx4 v[160:163], v5, s[4:7], s50 offen offset:0 nt
    s_waitcnt vmcnt(2)
    buffer_load_dwordx4 v[164:167], v5, s[4:7], s50 offen offset:128 nt
    s_cmp_lg_u32 s3, 0
    s_cbranch_scc1 L_HS51
    s_cmp_lg_u32 s46, 0
    s_cbranch_scc1 L_HS51
    s_mov_b32 s76, 0
    s_cmp_lg_u32 s47, 0
    s_cbranch_scc1 L_HH52
    s_waitcnt vmcnt(2)
L_HR53:
    v_readfirstlane_b32 s47, v58
    s_cmp_eq_u32 s47, 0
    s_cselect_b32 s47, s96, s47
    s_cmp_lg_u32 s47, 0
    s_cbranch_scc1 L_HG54
    buffer_load_dword v58, off, s[28:31], 0 sc1
    s_branch L_HS51
L_HG54:
    v_mov_b32 v56, 0
    v_mov_b32 v59, s47
    ds_write_b32 v56, v59 offset:10968
L_HH52:
    v_mov_b32 v56, 0
L_HQ55:
    ds_read_b64 v[96:97], v56 offset:10960
    s_waitcnt lgkmcnt(0)
    v_readfirstlane_b32 s64, v96
    v_readfirstlane_b32 s65, v97
    s_add_u32 s64, s64, s65
    s_cmp_eq_u32 s64, 16
    s_cbranch_scc0 L_HS51
    v_and_b32 v56, 1, v3
    v_lshlrev_b32 v59, 11, v56
    v_lshl_add_u32 v59, v4, 4, v59
    ds_read_b128 v[64:67], v59 offset:0
    ds_read_b128 v[68:71], v59 offset:256
    ds_read_b128 v[72:75], v59 offset:512
    ds_read_b128 v[76:79], v59 offset:768
    ds_read_b128 v[80:83], v59 offset:1024
    ds_read_b128 v[84:87], v59 offset:1280
    ds_read_b128 v[88:91], v59 offset:1536
    ds_read_b128 v[92:95], v59 offset:1792
    v_mov_b32 v15, s47
    v_and_b32 v12, 0xff, v15
    v_bfe_u32 v13, v15, 8, 8
    v_bfe_u32 v14, v15, 16, 8
    v_lshrrev_b32 v15, 24, v15
    v_mov_b32 v59, s92
    v_mov_b32 v96, s93
    v_cmp_ne_u32 vcc, 0, v56
    s_nop 1
    v_cndmask_b32 v59, v59, v96, vcc
    v_lshl_add_u32 v59, v4, 4, v59
    s_waitcnt lgkmcnt(0)
    v_pk_add_f32 v[64:65], v[64:65], v[68:69]
    v_pk_add_f32 v[66:67], v[66:67], v[70:71]
    v_pk_add_f32 v[72:73], v[72:73], v[76:77]
    v_pk_add_f32 v[74:75], v[74:75], v[78:79]
    v_pk_add_f32 v[80:81], v[80:81], v[84:85]
    v_pk_add_f32 v[82:83], v[82:83], v[86:87]
    v_pk_add_f32 v[88:89], v[88:89], v[92:93]
    v_pk_add_f32 v[90:91], v[90:91], v[94:95]
    v_pk_add_f32 v[64:65], v[64:65], v[72:73]
    v_pk_add_f32 v[66:67], v[66:67], v[74:75]
    v_pk_add_f32 v[80:81], v[80:81], v[88:89]
    v_pk_add_f32 v[82:83], v[82:83], v[90:91]
    v_pk_add_f32 v[64:65], v[64:65], v[80:81]
    v_pk_add_f32 v[66:67], v[66:67], v[82:83]
    v_bfi_b32 v64, s77, v64, v12
    v_bfi_b32 v65, s77, v65, v13
    v_bfi_b32 v66, s77, v66, v14
    v_bfi_b32 v67, s77, v67, v15
    s_mov_b64 exec, 0xffffffff
    buffer_store_dwordx4 v[64:67], v59, s[12:15], 0 offen sc1
    s_mov_b64 exec, -1
    s_mov_b32 s46, 1
L_HS51:
    s_waitcnt vmcnt(2)
    buffer_load_dwordx4 v[168:171], v5, s[4:7], s50 offen offset:512 nt
    s_cmp_lg_u32 s3, 0
    s_cbranch_scc1 L_PI56
    v_lshlrev_b32 v56, 5, v1
    buffer_load_dwordx4 v[100:103], v56, s[16:19], 0 offen
    buffer_load_dwordx4 v[104:107], v56, s[16:19], 0 offen offset:16
    buffer_load_dwordx4 v[108:111], v56, s[36:39], 0 offen
    buffer_load_dwordx4 v[112:115], v56, s[36:39], 0 offen offset:16
    buffer_load_dwordx4 v[116:119], v56, s[40:43], 0 offen
    buffer_load_dwordx4 v[120:123], v56, s[40:43], 0 offen offset:16
L_PI56:
    s_waitcnt vmcnt(2)
    buffer_load_dwordx4 v[172:175], v5, s[4:7], s50 offen offset:640 nt
    s_waitcnt vmcnt(2)
    buffer_load_dwordx4 v[176:179], v5, s[4:7], s51 offen offset:0 nt
    s_waitcnt vmcnt(2)
    buffer_load_dwordx4 v[180:183], v5, s[4:7], s51 offen offset:128 nt
    s_cmp_lg_u32 s3, 0
    s_cbranch_scc1 L_HS57
    s_cmp_lg_u32 s46, 0
    s_cbranch_scc1 L_HS57
    s_mov_b32 s76, 0
    s_cmp_lg_u32 s47, 0
    s_cbranch_scc1 L_HH58
    s_waitcnt vmcnt(4)
L_HR59:
    v_readfirstlane_b32 s47, v58
    s_cmp_eq_u32 s47, 0
    s_cselect_b32 s47, s96, s47
    s_cmp_lg_u32 s47, 0
    s_cbranch_scc1 L_HG60
    buffer_load_dword v58, off, s[28:31], 0 sc1
    s_waitcnt vmcnt(0)
    s_add_u32 s76, s76, 1
    s_cmp_lt_u32 s76, 200000
    s_cbranch_scc1 L_HR59
    s_mov_b32 s47, 1
L_HG60:
    v_mov_b32 v56, 0
    v_mov_b32 v59, s47
    ds_write_b32 v56, v59 offset:10968
L_HH58:
    v_mov_b32 v56, 0
L_HQ61:
    ds_read_b64 v[96:97], v56 offset:10960
    s_waitcnt lgkmcnt(0)
    v_readfirstlane_b32 s64, v96
    v_readfirstlane_b32 s65, v97
    s_add_u32 s64, s64, s65
    s_cmp_eq_u32 s64, 16
    s_cbranch_scc1 L_HO62
    s_add_u32 s76, s76, 1
    s_cmp_lt_u32 s76, 4000000
    s_cbranch_scc1 L_HQ61
L_HO62:
    v_and_b32 v56, 1, v3
    v_lshlrev_b32 v59, 11, v56
    v_lshl_add_u32 v59, v4, 4, v59
    ds_read_b128 v[64:67], v59 offset:0
    ds_read_b128 v[68:71], v59 offset:256
    ds_read_b128 v[72:75], v59 offset:512
    ds_read_b128 v[76:79], v59 offset:768
    ds_read_b128 v[80:83], v59 offset:1024
    ds_read_b128 v[84:87], v59 offset:1280
    ds_read_b128 v[88:91], v59 offset:1536
    ds_read_b128 v[92:95], v59 offset:1792
    v_mov_b32 v15, s47
    v_and_b32 v12, 0xff, v15
    v_bfe_u32 v13, v15, 8, 8
    v_bfe_u32 v14, v15, 16, 8
    v_lshrrev_b32 v15, 24, v15
    v_mov_b32 v59, s92
    v_mov_b32 v96, s93
    v_cmp_ne_u32 vcc, 0, v56
    s_nop 1
    v_cndmask_b32 v59, v59, v96, vcc
    v_lshl_add_u32 v59, v4, 4, v59
    s_waitcnt lgkmcnt(0)
    v_pk_add_f32 v[64:65], v[64:65], v[68:69]
    v_pk_add_f32 v[66:67], v[66:67], v[70:71]
    v_pk_add_f32 v[72:73], v[72:73], v[76:77]
    v_pk_add_f32 v[74:75], v[74:75], v[78:79]
    v_pk_add_f32 v[80:81], v[80:81], v[84:85]
    v_pk_add_f32 v[82:83], v[82:83], v[86:87]
    v_pk_add_f32 v[88:89], v[88:89], v[92:93]
    v_pk_add_f32 v[90:91], v[90:91], v[94:95]
    v_pk_add_f32 v[64:65], v[64:65], v[72:73]
    v_pk_add_f32 v[66:67], v[66:67], v[74:75]
    v_pk_add_f32 v[80:81], v[80:81], v[88:89]
    v_pk_add_f32 v[82:83], v[82:83], v[90:91]
    v_pk_add_f32 v[64:65], v[64:65], v[80:81]
    v_pk_add_f32 v[66:67], v[66:67], v[82:83]
    v_bfi_b32 v64, s77, v64, v12
    v_bfi_b32 v65, s77, v65, v13
    v_bfi_b32 v66, s77, v66, v14
    v_bfi_b32 v67, s77, v67, v15
    s_mov_b64 exec, 0xffffffff
    buffer_store_dwordx4 v[64:67], v59, s[12:15], 0 offen sc1
    s_mov_b64 exec, -1
    s_mov_b32 s46, 1
L_HS57:
    s_waitcnt vmcnt(2)
    buffer_load_dwordx4 v[184:187], v5, s[4:7], s51 offen offset:512 nt
    s_cmp_lg_u32 s3, 0
    s_cbranch_scc1 L_PC63
    s_waitcnt vmcnt(4)
    v_mov_b32 v64, 0
    v_mov_b32 v65, 0
    v_dot2c_f32_bf16 v64, v100, v108
    v_dot2c_f32_bf16 v64, v101, v109
    v_dot2c_f32_bf16 v64, v102, v110
    v_dot2c_f32_bf16 v64, v103, v111
    v_dot2c_f32_bf16 v64, v104, v112
    v_dot2c_f32_bf16 v64, v105, v113
    v_dot2c_f32_bf16 v64, v106, v114
    v_dot2c_f32_bf16 v64, v107, v115
    v_lshlrev_b32 v66, 16, v100
    v_and_b32 v67, 0xffff0000, v100
    v_lshlrev_b32 v68, 16, v116
    v_and_b32 v69, 0xffff0000, v116
    v_mul_f32 v66, v66, v68
    v_mul_f32 v67, v67, v69
    v_cvt_pk_bf16_f32 v66, v66, v67
    v_lshlrev_b32 v67, 16, v66
    v_and_b32 v66, 0xffff0000, v66
    v_add_f32 v65, v65, v66
    v_add_f32 v65, v65, v67
    v_lshlrev_b32 v66, 16, v101
    v_and_b32 v67, 0xffff0000, v101
    v_lshlrev_b32 v68, 16, v117
    v_and_b32 v69, 0xffff0000, v117
    v_mul_f32 v66, v66, v68
    v_mul_f32 v67, v67, v69
    v_cvt_pk_bf16_f32 v66, v66, v67
    v_lshlrev_b32 v67, 16, v66
    v_and_b32 v66, 0xffff0000, v66
    v_add_f32 v65, v65, v66
    v_add_f32 v65, v65, v67
    v_lshlrev_b32 v66, 16, v102
    v_and_b32 v67, 0xffff0000, v102
    v_lshlrev_b32 v68, 16, v118
    v_and_b32 v69, 0xffff0000, v118
    v_mul_f32 v66, v66, v68
    v_mul_f32 v67, v67, v69
    v_cvt_pk_bf16_f32 v66, v66, v67
    v_lshlrev_b32 v67, 16, v66
    v_and_b32 v66, 0xffff0000, v66
    v_add_f32 v65, v65, v66
    v_add_f32 v65, v65, v67
    v_lshlrev_b32 v66, 16, v103
    v_and_b32 v67, 0xffff0000, v103
    v_lshlrev_b32 v68, 16, v119
    v_and_b32 v69, 0xffff0000, v119
    v_mul_f32 v66, v66, v68
    v_mul_f32 v67, v67, v69
    v_cvt_pk_bf16_f32 v66, v66, v67
    v_lshlrev_b32 v67, 16, v66
    v_and_b32 v66, 0xffff0000, v66
    v_add_f32 v65, v65, v66
    v_add_f32 v65, v65, v67
    v_lshlrev_b32 v66, 16, v104
    v_and_b32 v67, 0xffff0000, v104
    v_lshlrev_b32 v68, 16, v120
    v_and_b32 v69, 0xffff0000, v120
    v_mul_f32 v66, v66, v68
    v_mul_f32 v67, v67, v69
    v_cvt_pk_bf16_f32 v66, v66, v67
    v_lshlrev_b32 v67, 16, v66
    v_and_b32 v66, 0xffff0000, v66
    v_add_f32 v65, v65, v66
    v_add_f32 v65, v65, v67
    v_lshlrev_b32 v66, 16, v105
    v_and_b32 v67, 0xffff0000, v105
    v_lshlrev_b32 v68, 16, v121
    v_and_b32 v69, 0xffff0000, v121
    v_mul_f32 v66, v66, v68
    v_mul_f32 v67, v67, v69
    v_cvt_pk_bf16_f32 v66, v66, v67
    v_lshlrev_b32 v67, 16, v66
    v_and_b32 v66, 0xffff0000, v66
    v_add_f32 v65, v65, v66
    v_add_f32 v65, v65, v67
    v_lshlrev_b32 v66, 16, v106
    v_and_b32 v67, 0xffff0000, v106
    v_lshlrev_b32 v68, 16, v122
    v_and_b32 v69, 0xffff0000, v122
    v_mul_f32 v66, v66, v68
    v_mul_f32 v67, v67, v69
    v_cvt_pk_bf16_f32 v66, v66, v67
    v_lshlrev_b32 v67, 16, v66
    v_and_b32 v66, 0xffff0000, v66
    v_add_f32 v65, v65, v66
    v_add_f32 v65, v65, v67
    v_lshlrev_b32 v66, 16, v107
    v_and_b32 v67, 0xffff0000, v107
    v_lshlrev_b32 v68, 16, v123
    v_and_b32 v69, 0xffff0000, v123
    v_mul_f32 v66, v66, v68
    v_mul_f32 v67, v67, v69
    v_cvt_pk_bf16_f32 v66, v66, v67
    v_lshlrev_b32 v67, 16, v66
    v_and_b32 v66, 0xffff0000, v66
    v_add_f32 v65, v65, v66
    v_add_f32 v65, v65, v67
    s_nop 1
    v_add_f32_dpp v64, v64, v64 row_ror:8 row_mask:0xf bank_mask:0xf
    v_add_f32_dpp v65, v65, v65 row_ror:8 row_mask:0xf bank_mask:0xf
    s_nop 1
    v_add_f32_dpp v64, v64, v64 row_ror:4 row_mask:0xf bank_mask:0xf
    v_add_f32_dpp v65, v65, v65 row_ror:4 row_mask:0xf bank_mask:0xf
    s_nop 1
    v_add_f32_dpp v64, v64, v64 row_ror:2 row_mask:0xf bank_mask:0xf
    v_add_f32_dpp v65, v65, v65 row_ror:2 row_mask:0xf bank_mask:0xf
    s_nop 1
    v_add_f32_dpp v64, v64, v64 row_ror:1 row_mask:0xf bank_mask:0xf
    v_add_f32_dpp v65, v65, v65 row_ror:1 row_mask:0xf bank_mask:0xf
    v_mov_b32 v66, v64
    v_mov_b32 v67, v65
    s_nop 1
    v_permlane16_swap_b32 v64, v66
    v_permlane16_swap_b32 v65, v67
    v_add_f32 v64, v64, v66
    v_add_f32 v65, v65, v67
    v_mov_b32 v66, v64
    v_mov_b32 v67, v65
    s_nop 1
    v_permlane32_swap_b32 v64, v66
    v_permlane32_swap_b32 v65, v67
    v_add_f32 v64, v64, v66
    v_add_f32 v65, v65, v67
    v_cvt_pk_bf16_f32 v64, v64, v65
    v_and_b32 v65, 0xffff0000, v64
    v_lshlrev_b32 v64, 16, v64
    v_mul_f32 v64, 0xbfb8aa3b, v64
    v_mul_f32 v65, 0xbfb8aa3b, v65
    v_exp_f32 v64, v64
    v_exp_f32 v65, v65
    s_nop 0
    v_add_f32 v64, 1.0, v64
    v_add_f32 v65, 1.0, v65
    v_rcp_f32 v64, v64
    v_rcp_f32 v65, v65
    s_nop 0
    v_cvt_pk_bf16_f32 v64, v64, v65
    v_and_b32 v68, 0xffff0000, v64
    v_lshlrev_b32 v70, 16, v64
    v_sub_f32 v69, 1.0, v68
    v_cvt_pk_bf16_f32 v69, v69, v69
    v_lshlrev_b32 v69, 16, v69
    v_mov_b32 v71, 1
    v_mov_b32 v56, 0
    ds_write_b128 v56, v[68:71] offset:10944
L_PC63:
    s_waitcnt vmcnt(2)
    buffer_load_dwordx4 v[188:191], v5, s[4:7], s51 offen offset:640 nt
    s_waitcnt vmcnt(2)
    buffer_load_dwordx4 v[192:195], v5, s[4:7], s52 offen offset:0 nt
    s_waitcnt vmcnt(2)
    buffer_load_dwordx4 v[196:199], v5, s[4:7], s52 offen offset:128 nt
    s_waitcnt vmcnt(2)
    buffer_load_dwordx4 v[200:203], v5, s[4:7], s52 offen offset:512 nt
    s_waitcnt vmcnt(2)
    buffer_load_dwordx4 v[204:207], v5, s[4:7], s52 offen offset:640 nt
    s_waitcnt vmcnt(2)
    buffer_load_dwordx4 v[208:211], v5, s[4:7], s53 offen offset:0 nt
    v_lshlrev_b32 v10, 4, v1
    buffer_load_dwordx4 v[32:35], v10, s[12:15], s82 offen sc1
    buffer_load_dwordx4 v[36:39], v10, s[12:15], s82 offen offset:1024 sc1
    s_waitcnt vmcnt(2)
    buffer_load_dwordx4 v[212:215], v5, s[4:7], s53 offen offset:128 nt
    s_waitcnt vmcnt(2)
    buffer_load_dwordx4 v[216:219], v5, s[4:7], s53 offen offset:512 nt
    s_waitcnt vmcnt(2)
    buffer_load_dwordx4 v[220:223], v5, s[4:7], s53 offen offset:640 nt
    v_mov_b32 v56, 0
    s_mov_b32 s76, 0
L_SP64:
    ds_read_b32 v59, v56 offset:10968
    s_waitcnt lgkmcnt(0)
    v_readfirstlane_b32 s47, v59
    s_cmp_lg_u32 s47, 0
    s_cbranch_scc1 L_SPD65
    s_sleep 1
    s_add_u32 s76, s76, 1
    s_cmp_lt_u32 s76, 4000000
    s_cbranch_scc1 L_SP64
L_SPD65:
    v_mov_b32 v15, s47
    v_and_b32 v12, 0xff, v15
    v_bfe_u32 v13, v15, 8, 8
    v_bfe_u32 v14, v15, 16, 8
    v_lshrrev_b32 v15, 24, v15
    s_waitcnt vmcnt(3)
    s_mov_b32 s76, 0
L_QL66:
    v_xor_b32 v32, v12, v32
    v_xor_b32 v33, v13, v33
    v_xor_b32 v34, v14, v34
    v_xor_b32 v35, v15, v35
    v_xor_b32 v36, v12, v36
    v_xor_b32 v37, v13, v37
    v_xor_b32 v38, v14, v38
    v_xor_b32 v39, v15, v39
    v_or3_b32 v56, v32, v33, v34
    v_or_b32 v56, v56, v35
    v_or3_b32 v56, v56, v36, v37
    v_or3_b32 v56, v56, v38, v39
    v_and_b32 v56, 0xff, v56
    v_cmp_ne_u32 vcc, 0, v56
    s_mov_b64 exec, -1
    s_cbranch_vccz L_QD67
    s_add_u32 s76, s76, 1
    s_cmp_lt_u32 s76, 200000
    s_cbranch_scc0 L_QD67
    s_sleep 1
    s_mov_b64 exec, vcc
    buffer_load_dwordx4 v[32:35], v10, s[12:15], s82 offen sc1
    buffer_load_dwordx4 v[36:39], v10, s[12:15], s82 offen offset:1024 sc1
    s_waitcnt vmcnt(0)
    s_branch L_QL66
L_QD67:
    v_pk_add_f32 v[32:33], v[32:33], v[36:37]
    v_pk_add_f32 v[34:35], v[34:35], v[38:39]
    v_mov_b32 v36, v32
    v_mov_b32 v37, v33
    v_mov_b32 v38, v34
    v_mov_b32 v39, v35
    s_nop 1
    v_permlane32_swap_b32 v32, v36
    v_permlane32_swap_b32 v33, v37
    v_permlane32_swap_b32 v34, v38
    v_permlane32_swap_b32 v35, v39
    v_add_f32 v32, v32, v36
    v_add_f32 v33, v33, v37
    v_add_f32 v34, v34, v38
    v_add_f32 v35, v35, v39
    v_cvt_pk_bf16_f32 v32, v32, v33
    v_cvt_pk_bf16_f32 v33, v34, v35
    v_and_b32 v56, 31, v1
    v_lshlrev_b32 v56, 3, v56
    s_mul_i32 s64, s3, 272
    v_add_u32 v56, s64, v56
    ds_write_b64 v56, v[32:33] offset:8192
    v_mov_b32 v56, 0
    v_mov_b32 v59, 1
    s_waitcnt lgkmcnt(0)
    s_mov_b64 exec, 1
    ds_add_u32 v56, v59 offset:10972
    s_mov_b64 exec, -1
    s_waitcnt vmcnt(2)
    buffer_load_dwordx4 v[224:227], v5, s[4:7], s54 offen offset:0 nt
    s_waitcnt vmcnt(2)
    buffer_load_dwordx4 v[228:231], v5, s[4:7], s54 offen offset:128 nt
    s_waitcnt vmcnt(2)
    buffer_load_dwordx4 v[232:235], v5, s[4:7], s54 offen offset:512 nt
    s_waitcnt vmcnt(2)
    buffer_load_dwordx4 v[236:239], v5, s[4:7], s54 offen offset:640 nt
    s_waitcnt vmcnt(2)
    buffer_load_dwordx4 v[240:243], v5, s[4:7], s55 offen offset:0 nt
    s_waitcnt vmcnt(2)
    buffer_load_dwordx4 v[244:247], v5, s[4:7], s55 offen offset:128 nt
    s_waitcnt vmcnt(2)
    buffer_load_dwordx4 v[248:251], v5, s[4:7], s55 offen offset:512 nt
    s_waitcnt vmcnt(2)
    buffer_load_dwordx4 v[252:255], v5, s[4:7], s55 offen offset:640 nt
    s_waitcnt vmcnt(2)
    buffer_load_dwordx4 v[64:67], v6, s[8:11], s48 offen offset:0 nt
    s_waitcnt vmcnt(2)
    buffer_load_dwordx4 v[68:71], v6, s[8:11], s48 offen offset:256 nt
    s_waitcnt vmcnt(2)
    buffer_load_dwordx4 v[72:75], v6, s[8:11], s48 offen offset:512 nt
    v_and_b32 v10, 7, v1
    v_mul_u32_u24 v10, 272, v10
    v_bfe_u32 v11, v1, 3, 1
    v_lshl_add_u32 v10, v11, 4, v10
    v_lshl_add_u32 v10, v3, 5, v10
    v_mov_b32 v61, 0xffff
    v_lshlrev_b32 v11, 4, v11
    v_lshlrev_b32 v61, v11, v61
    v_lshlrev_b32 v2, 13, v3
    v_lshl_add_u32 v2, v4, 4, v2
    v_mov_b32 v56, 0
    s_mov_b32 s76, 0
L_SP68:
    ds_read_b32 v59, v56 offset:10972
    s_waitcnt lgkmcnt(0)
    v_readfirstlane_b32 s64, v59
    s_cmp_ge_u32 s64, 8
    s_cbranch_scc1 L_SPD69
    s_sleep 1
    s_add_u32 s76, s76, 1
    s_cmp_lt_u32 s76, 4000000
    s_cbranch_scc1 L_SP68
L_SPD69:
    ds_read_b128 v[48:51], v10 offset:8192
    ds_read_b128 v[52:55], v10 offset:8320
    s_waitcnt lgkmcnt(0)
    s_waitcnt vmcnt(33)
    v_mfma_f32_16x16x32_bf16 v[32:35], v[128:131], v[48:51], 0
    v_mfma_f32_16x16x32_bf16 v[36:39], v[136:139], v[48:51], 0
    v_mfma_f32_16x16x32_bf16 v[32:35], v[132:135], v[52:55], v[32:35]
    v_mfma_f32_16x16x32_bf16 v[36:39], v[140:143], v[52:55], v[36:39]
    s_waitcnt vmcnt(29)
    v_mfma_f32_16x16x32_bf16 v[40:43], v[144:147], v[48:51], 0
    v_mfma_f32_16x16x32_bf16 v[44:47], v[152:155], v[48:51], 0
    v_mfma_f32_16x16x32_bf16 v[40:43], v[148:151], v[52:55], v[40:43]
    v_mfma_f32_16x16x32_bf16 v[44:47], v[156:159], v[52:55], v[44:47]
    s_nop 3
    v_add_f32_dpp v16, v33, v32 row_ror:8 row_mask:0xf bank_mask:0x3
    v_add_f32_dpp v16, v34, v35 row_ror:8 row_mask:0xf bank_mask:0xc
    v_add_f32_dpp v17, v37, v36 row_ror:8 row_mask:0xf bank_mask:0x3
    v_add_f32_dpp v17, v38, v39 row_ror:8 row_mask:0xf bank_mask:0xc
    s_waitcnt vmcnt(2)
    buffer_load_dwordx4 v[76:79], v6, s[8:11], s48 offen offset:768 nt
    s_waitcnt vmcnt(26)
    v_mfma_f32_16x16x32_bf16 v[32:35], v[160:163], v[48:51], 0
    v_mfma_f32_16x16x32_bf16 v[36:39], v[168:171], v[48:51], 0
    v_mfma_f32_16x16x32_bf16 v[32:35], v[164:167], v[52:55], v[32:35]
    v_mfma_f32_16x16x32_bf16 v[36:39], v[172:175], v[52:55], v[36:39]
    v_add_f32_dpp v18, v41, v40 row_ror:8 row_mask:0xf bank_mask:0x3
    v_add_f32_dpp v18, v42, v43 row_ror:8 row_mask:0xf bank_mask:0xc
    v_add_f32_dpp v19, v45, v44 row_ror:8 row_mask:0xf bank_mask:0x3
    v_add_f32_dpp v19, v46, v47 row_ror:8 row_mask:0xf bank_mask:0xc
    s_waitcnt vmcnt(22)
    v_mfma_f32_16x16x32_bf16 v[40:43], v[176:179], v[48:51], 0
    v_mfma_f32_16x16x32_bf16 v[44:47], v[184:187], v[48:51], 0
    v_mfma_f32_16x16x32_bf16 v[40:43], v[180:183], v[52:55], v[40:43]
    v_mfma_f32_16x16x32_bf16 v[44:47], v[188:191], v[52:55], v[44:47]
    v_add_f32_dpp v20, v33, v32 row_ror:8 row_mask:0xf bank_mask:0x3
    v_add_f32_dpp v20, v34, v35 row_ror:8 row_mask:0xf bank_mask:0xc
    v_add_f32_dpp v21, v37, v36 row_ror:8 row_mask:0xf bank_mask:0x3
    v_add_f32_dpp v21, v38, v39 row_ror:8 row_mask:0xf bank_mask:0xc
    s_waitcnt vmcnt(2)
    buffer_load_dwordx4 v[80:83], v6, s[8:11], s49 offen offset:0 nt
    s_waitcnt vmcnt(19)
    v_mfma_f32_16x16x32_bf16 v[32:35], v[192:195], v[48:51], 0
    v_mfma_f32_16x16x32_bf16 v[36:39], v[200:203], v[48:51], 0
    v_mfma_f32_16x16x32_bf16 v[32:35], v[196:199], v[52:55], v[32:35]
    v_mfma_f32_16x16x32_bf16 v[36:39], v[204:207], v[52:55], v[36:39]
    v_add_f32_dpp v22, v41, v40 row_ror:8 row_mask:0xf bank_mask:0x3
    v_add_f32_dpp v22, v42, v43 row_ror:8 row_mask:0xf bank_mask:0xc
    v_add_f32_dpp v23, v45, v44 row_ror:8 row_mask:0xf bank_mask:0x3
    v_add_f32_dpp v23, v46, v47 row_ror:8 row_mask:0xf bank_mask:0xc
    s_waitcnt vmcnt(13)
    v_mfma_f32_16x16x32_bf16 v[40:43], v[208:211], v[48:51], 0
    v_mfma_f32_16x16x32_bf16 v[44:47], v[216:219], v[48:51], 0
    v_mfma_f32_16x16x32_bf16 v[40:43], v[212:215], v[52:55], v[40:43]
    v_mfma_f32_16x16x32_bf16 v[44:47], v[220:223], v[52:55], v[44:47]
    v_add_f32_dpp v24, v33, v32 row_ror:8 row_mask:0xf bank_mask:0x3
    v_add_f32_dpp v24, v34, v35 row_ror:8 row_mask:0xf bank_mask:0xc
    v_add_f32_dpp v25, v37, v36 row_ror:8 row_mask:0xf bank_mask:0x3
    v_add_f32_dpp v25, v38, v39 row_ror:8 row_mask:0xf bank_mask:0xc
    s_waitcnt vmcnt(2)
    buffer_load_dwordx4 v[84:87], v6, s[8:11], s49 offen offset:256 nt
    s_waitcnt vmcnt(10)
    v_mfma_f32_16x16x32_bf16 v[32:35], v[224:227], v[48:51], 0
    v_mfma_f32_16x16x32_bf16 v[36:39], v[232:235], v[48:51], 0
    v_mfma_f32_16x16x32_bf16 v[32:35], v[228:231], v[52:55], v[32:35]
    v_mfma_f32_16x16x32_bf16 v[36:39], v[236:239], v[52:55], v[36:39]
    v_add_f32_dpp v26, v41, v40 row_ror:8 row_mask:0xf bank_mask:0x3
    v_add_f32_dpp v26, v42, v43 row_ror:8 row_mask:0xf bank_mask:0xc
    v_add_f32_dpp v27, v45, v44 row_ror:8 row_mask:0xf bank_mask:0x3
    v_add_f32_dpp v27, v46, v47 row_ror:8 row_mask:0xf bank_mask:0xc
    s_waitcnt vmcnt(6)
    v_mfma_f32_16x16x32_bf16 v[40:43], v[240:243], v[48:51], 0
    v_mfma_f32_16x16x32_bf16 v[44:47], v[248:251], v[48:51], 0
    v_mfma_f32_16x16x32_bf16 v[40:43], v[244:247], v[52:55], v[40:43]
    v_mfma_f32_16x16x32_bf16 v[44:47], v[252:255], v[52:55], v[44:47]
    v_add_f32_dpp v28, v33, v32 row_ror:8 row_mask:0xf bank_mask:0x3
    v_add_f32_dpp v28, v34, v35 row_ror:8 row_mask:0xf bank_mask:0xc
    v_add_f32_dpp v29, v37, v36 row_ror:8 row_mask:0xf bank_mask:0x3
    v_add_f32_dpp v29, v38, v39 row_ror:8 row_mask:0xf bank_mask:0xc
    s_waitcnt vmcnt(2)
    buffer_load_dwordx4 v[88:91], v6, s[8:11], s49 offen offset:512 nt
    s_nop 7
    v_add_f32_dpp v30, v41, v40 row_ror:8 row_mask:0xf bank_mask:0x3
    v_add_f32_dpp v30, v42, v43 row_ror:8 row_mask:0xf bank_mask:0xc
    v_add_f32_dpp v31, v45, v44 row_ror:8 row_mask:0xf bank_mask:0x3
    v_add_f32_dpp v31, v46, v47 row_ror:8 row_mask:0xf bank_mask:0xc
    v_mov_b32 v192, 0
    v_mov_b32 v193, 0
    v_mov_b32 v194, 0
    v_mov_b32 v195, 0
    v_mov_b32 v196, 0
    v_mov_b32 v197, 0
    v_mov_b32 v198, 0
    v_mov_b32 v199, 0
    v_mov_b32 v200, 0
    v_mov_b32 v201, 0
    v_mov_b32 v202, 0
    v_mov_b32 v203, 0
    v_mov_b32 v204, 0
    v_mov_b32 v205, 0
    v_mov_b32 v206, 0
    v_mov_b32 v207, 0
    v_mov_b32 v208, 0
    v_mov_b32 v209, 0
    v_mov_b32 v210, 0
    v_mov_b32 v211, 0
    v_mov_b32 v212, 0
    v_mov_b32 v213, 0
    v_mov_b32 v214, 0
    v_mov_b32 v215, 0
    v_mov_b32 v216, 0
    v_mov_b32 v217, 0
    v_mov_b32 v218, 0
    v_mov_b32 v219, 0
    v_mov_b32 v220, 0
    v_mov_b32 v221, 0
    v_mov_b32 v222, 0
    v_mov_b32 v223, 0
    s_waitcnt vmcnt(2)
    buffer_load_dwordx4 v[92:95], v6, s[8:11], s49 offen offset:768 nt
    v_max3_f32 v8, v16, v17, v18
    v_max3_f32 v8, v8, v19, v20
    v_max3_f32 v8, v8, v21, v22
    v_max3_f32 v8, v8, v23, v24
    v_max3_f32 v8, v8, v25, v26
    v_max3_f32 v8, v8, v27, v28
    v_max3_f32 v8, v8, v29, v30
    v_max_f32 v8, v8, v31
    s_nop 1
    v_max_f32_dpp v8, v8, v8 row_ror:8 row_mask:0xf bank_mask:0xf
    v_mov_b32 v10, v8
    s_nop 1
    v_permlane16_swap_b32 v8, v10
    v_max_f32 v8, v8, v10
    v_mov_b32 v10, v8
    s_nop 1
    v_permlane32_swap_b32 v8, v10
    v_max_f32 v8, v8, v10
    v_mul_f32 v8, 0x3e0293ee, v8
    v_mov_b32 v11, 0x3e0293ee
    v_mov_b32 v9, 0
    v_and_b32 v10, 7, v1
    v_lshlrev_b32 v10, 5, v10
    s_lshl_b32 s64, s3, 2
    v_add_u32 v60, s64, v10
    ds_write_b32 v60, v8 offset:10368
    v_fma_f32 v16, v16, v11, -v8
    v_fma_f32 v17, v17, v11, -v8
    v_fma_f32 v18, v18, v11, -v8
    v_fma_f32 v19, v19, v11, -v8
    v_fma_f32 v20, v20, v11, -v8
    v_fma_f32 v21, v21, v11, -v8
    v_fma_f32 v22, v22, v11, -v8
    v_fma_f32 v23, v23, v11, -v8
    v_fma_f32 v24, v24, v11, -v8
    v_fma_f32 v25, v25, v11, -v8
    v_fma_f32 v26, v26, v11, -v8
    v_fma_f32 v27, v27, v11, -v8
    v_fma_f32 v28, v28, v11, -v8
    v_fma_f32 v29, v29, v11, -v8
    v_fma_f32 v30, v30, v11, -v8
    v_fma_f32 v31, v31, v11, -v8
    v_mov_b32 v56, 0
    v_mov_b32 v59, 1
    s_waitcnt lgkmcnt(0)
    s_mov_b64 exec, 1
    ds_add_u32 v56, v59 offset:10976
    s_mov_b64 exec, -1
    s_waitcnt vmcnt(2)
    buffer_load_dwordx4 v[96:99], v6, s[8:11], s50 offen offset:0 nt
    v_exp_f32 v16, v16
    v_exp_f32 v17, v17
    v_exp_f32 v18, v18
    v_exp_f32 v19, v19
    v_exp_f32 v20, v20
    v_exp_f32 v21, v21
    v_exp_f32 v22, v22
    v_exp_f32 v23, v23
    v_exp_f32 v24, v24
    v_exp_f32 v25, v25
    v_exp_f32 v26, v26
    v_exp_f32 v27, v27
    v_exp_f32 v28, v28
    v_exp_f32 v29, v29
    v_exp_f32 v30, v30
    v_exp_f32 v31, v31
    s_nop 0
    v_cvt_pk_bf16_f32 v240, v16, v16
    v_cvt_pk_bf16_f32 v241, v17, v17
    v_cvt_pk_bf16_f32 v242, v18, v18
    v_cvt_pk_bf16_f32 v243, v19, v19
    v_cvt_pk_bf16_f32 v244, v20, v20
    v_cvt_pk_bf16_f32 v245, v21, v21
    v_cvt_pk_bf16_f32 v246, v22, v22
    v_cvt_pk_bf16_f32 v247, v23, v23
    v_cvt_pk_bf16_f32 v248, v24, v24
    v_cvt_pk_bf16_f32 v249, v25, v25
    v_cvt_pk_bf16_f32 v250, v26, v26
    v_cvt_pk_bf16_f32 v251, v27, v27
    v_cvt_pk_bf16_f32 v252, v28, v28
    v_cvt_pk_bf16_f32 v253, v29, v29
    v_cvt_pk_bf16_f32 v254, v30, v30
    v_cvt_pk_bf16_f32 v255, v31, v31
    s_waitcnt vmcnt(2)
    buffer_load_dwordx4 v[100:103], v6, s[8:11], s50 offen offset:256 nt
    v_and_b32 v240, v61, v240
    v_and_b32 v241, v61, v241
    v_and_b32 v242, v61, v242
    v_and_b32 v243, v61, v243
    v_and_b32 v244, v61, v244
    v_and_b32 v245, v61, v245
    v_and_b32 v246, v61, v246
    v_and_b32 v247, v61, v247
    v_and_b32 v248, v61, v248
    v_and_b32 v249, v61, v249
    v_and_b32 v250, v61, v250
    v_and_b32 v251, v61, v251
    v_and_b32 v252, v61, v252
    v_and_b32 v253, v61, v253
    v_and_b32 v254, v61, v254
    v_and_b32 v255, v61, v255
    v_dot2c_f32_bf16 v9, s81, v240
    v_dot2c_f32_bf16 v9, s81, v241
    v_dot2c_f32_bf16 v9, s81, v242
    v_dot2c_f32_bf16 v9, s81, v243
    v_dot2c_f32_bf16 v9, s81, v244
    v_dot2c_f32_bf16 v9, s81, v245
    v_dot2c_f32_bf16 v9, s81, v246
    v_dot2c_f32_bf16 v9, s81, v247
    v_dot2c_f32_bf16 v9, s81, v248
    v_dot2c_f32_bf16 v9, s81, v249
    v_dot2c_f32_bf16 v9, s81, v250
    v_dot2c_f32_bf16 v9, s81, v251
    v_dot2c_f32_bf16 v9, s81, v252
    v_dot2c_f32_bf16 v9, s81, v253
    v_dot2c_f32_bf16 v9, s81, v254
    v_dot2c_f32_bf16 v9, s81, v255
    s_nop 1
    s_nop 1
    v_add_f32_dpp v9, v9, v9 row_ror:8 row_mask:0xf bank_mask:0xf
    v_mov_b32 v10, v9
    s_nop 1
    v_permlane16_swap_b32 v9, v10
    v_add_f32 v9, v9, v10
    v_mov_b32 v10, v9
    s_nop 1
    v_permlane32_swap_b32 v9, v10
    v_add_f32 v9, v9, v10
    s_waitcnt vmcnt(2)
    buffer_load_dwordx4 v[104:107], v6, s[8:11], s50 offen offset:512 nt
    s_waitcnt vmcnt(3)
    v_perm_b32 v224, v68, v64, s72
    v_perm_b32 v228, v68, v64, s73
    v_perm_b32 v225, v76, v72, s72
    v_perm_b32 v229, v76, v72, s73
    v_perm_b32 v226, v84, v80, s72
    v_perm_b32 v230, v84, v80, s73
    v_perm_b32 v227, v92, v88, s72
    v_perm_b32 v231, v92, v88, s73
    s_nop 1
    v_mfma_f32_16x16x32_bf16 v[192:195], v[224:227], v[240:243], v[192:195]
    v_mfma_f32_16x16x32_bf16 v[196:199], v[228:231], v[240:243], v[196:199]
    v_perm_b32 v232, v69, v65, s72
    v_perm_b32 v236, v69, v65, s73
    v_perm_b32 v233, v77, v73, s72
    v_perm_b32 v237, v77, v73, s73
    v_perm_b32 v234, v85, v81, s72
    v_perm_b32 v238, v85, v81, s73
    v_perm_b32 v235, v93, v89, s72
    v_perm_b32 v239, v93, v89, s73
    s_nop 1
    v_mfma_f32_16x16x32_bf16 v[200:203], v[232:235], v[240:243], v[200:203]
    v_mfma_f32_16x16x32_bf16 v[204:207], v[236:239], v[240:243], v[204:207]
    s_waitcnt vmcnt(2)
    buffer_load_dwordx4 v[108:111], v6, s[8:11], s50 offen offset:768 nt
    v_perm_b32 v224, v70, v66, s72
    v_perm_b32 v228, v70, v66, s73
    v_perm_b32 v225, v78, v74, s72
    v_perm_b32 v229, v78, v74, s73
    v_perm_b32 v226, v86, v82, s72
    v_perm_b32 v230, v86, v82, s73
    v_perm_b32 v227, v94, v90, s72
    v_perm_b32 v231, v94, v90, s73
    s_nop 1
    v_mfma_f32_16x16x32_bf16 v[208:211], v[224:227], v[240:243], v[208:211]
    v_mfma_f32_16x16x32_bf16 v[212:215], v[228:231], v[240:243], v[212:215]
    v_perm_b32 v232, v71, v67, s72
    v_perm_b32 v236, v71, v67, s73
    v_perm_b32 v233, v79, v75, s72
    v_perm_b32 v237, v79, v75, s73
    v_perm_b32 v234, v87, v83, s72
    v_perm_b32 v238, v87, v83, s73
    v_perm_b32 v235, v95, v91, s72
    v_perm_b32 v239, v95, v91, s73
    s_nop 1
    v_mfma_f32_16x16x32_bf16 v[216:219], v[232:235], v[240:243], v[216:219]
    v_mfma_f32_16x16x32_bf16 v[220:223], v[236:239], v[240:243], v[220:223]
    s_waitcnt vmcnt(2)
    buffer_load_dwordx4 v[112:115], v6, s[8:11], s51 offen offset:0 nt
    s_waitcnt vmcnt(2)
    buffer_load_dwordx4 v[116:119], v6, s[8:11], s51 offen offset:256 nt
    s_waitcnt vmcnt(2)
    buffer_load_dwordx4 v[120:123], v6, s[8:11], s51 offen offset:512 nt
    s_waitcnt vmcnt(2)
    buffer_load_dwordx4 v[124:127], v6, s[8:11], s51 offen offset:768 nt
    s_waitcnt vmcnt(2)
    buffer_load_dwordx4 v[128:131], v6, s[8:11], s52 offen offset:0 nt
    s_waitcnt vmcnt(2)
    buffer_load_dwordx4 v[132:135], v6, s[8:11], s52 offen offset:256 nt
    s_waitcnt vmcnt(2)
    buffer_load_dwordx4 v[136:139], v6, s[8:11], s52 offen offset:512 nt
    s_waitcnt vmcnt(3)
    v_perm_b32 v224, v100, v96, s72
    v_perm_b32 v228, v100, v96, s73
    v_perm_b32 v225, v108, v104, s72
    v_perm_b32 v229, v108, v104, s73
    v_perm_b32 v226, v116, v112, s72
    v_perm_b32 v230, v116, v112, s73
    v_perm_b32 v227, v124, v120, s72
    v_perm_b32 v231, v124, v120, s73
    s_nop 1
    v_mfma_f32_16x16x32_bf16 v[192:195], v[224:227], v[244:247], v[192:195]
    v_mfma_f32_16x16x32_bf16 v[196:199], v[228:231], v[244:247], v[196:199]
    v_perm_b32 v232, v101, v97, s72
    v_perm_b32 v236, v101, v97, s73
    v_perm_b32 v233, v109, v105, s72
    v_perm_b32 v237, v109, v105, s73
    v_perm_b32 v234, v117, v113, s72
    v_perm_b32 v238, v117, v113, s73
    v_perm_b32 v235, v125, v121, s72
    v_perm_b32 v239, v125, v121, s73
    s_nop 1
    v_mfma_f32_16x16x32_bf16 v[200:203], v[232:235], v[244:247], v[200:203]
    v_mfma_f32_16x16x32_bf16 v[204:207], v[236:239], v[244:247], v[204:207]
    s_waitcnt vmcnt(2)
    buffer_load_dwordx4 v[140:143], v6, s[8:11], s52 offen offset:768 nt
    v_perm_b32 v224, v102, v98, s72
    v_perm_b32 v228, v102, v98, s73
    v_perm_b32 v225, v110, v106, s72
    v_perm_b32 v229, v110, v106, s73
    v_perm_b32 v226, v118, v114, s72
    v_perm_b32 v230, v118, v114, s73
    v_perm_b32 v227, v126, v122, s72
    v_perm_b32 v231, v126, v122, s73
    s_nop 1
    v_mfma_f32_16x16x32_bf16 v[208:211], v[224:227], v[244:247], v[208:211]
    v_mfma_f32_16x16x32_bf16 v[212:215], v[228:231], v[244:247], v[212:215]
    v_perm_b32 v232, v103, v99, s72
    v_perm_b32 v236, v103, v99, s73
    v_perm_b32 v233, v111, v107, s72
    v_perm_b32 v237, v111, v107, s73
    v_perm_b32 v234, v119, v115, s72
    v_perm_b32 v238, v119, v115, s73
    v_perm_b32 v235, v127, v123, s72
    v_perm_b32 v239, v127, v123, s73
    s_nop 1
    v_mfma_f32_16x16x32_bf16 v[216:219], v[232:235], v[244:247], v[216:219]
    v_mfma_f32_16x16x32_bf16 v[220:223], v[236:239], v[244:247], v[220:223]
    s_waitcnt vmcnt(2)
    buffer_load_dwordx4 v[144:147], v6, s[8:11], s53 offen offset:0 nt
    s_waitcnt vmcnt(2)
    buffer_load_dwordx4 v[148:151], v6, s[8:11], s53 offen offset:256 nt
    s_waitcnt vmcnt(2)
    buffer_load_dwordx4 v[152:155], v6, s[8:11], s53 offen offset:512 nt
    s_waitcnt vmcnt(2)
    buffer_load_dwordx4 v[156:159], v6, s[8:11], s53 offen offset:768 nt
    s_waitcnt vmcnt(2)
    buffer_load_dwordx4 v[160:163], v6, s[8:11], s54 offen offset:0 nt
    s_waitcnt vmcnt(2)
    buffer_load_dwordx4 v[164:167], v6, s[8:11], s54 offen offset:256 nt
    s_waitcnt vmcnt(2)
    buffer_load_dwordx4 v[168:171], v6, s[8:11], s54 offen offset:512 nt
    s_waitcnt vmcnt(3)
    v_perm_b32 v224, v132, v128, s72
    v_perm_b32 v228, v132, v128, s73
    v_perm_b32 v225, v140, v136, s72
    v_perm_b32 v229, v140, v136, s73
    v_perm_b32 v226, v148, v144, s72
    v_perm_b32 v230, v148, v144, s73
    v_perm_b32 v227, v156, v152, s72
    v_perm_b32 v231, v156, v152, s73
    s_nop 1
    v_mfma_f32_16x16x32_bf16 v[192:195], v[224:227], v[248:251], v[192:195]
    v_mfma_f32_16x16x32_bf16 v[196:199], v[228:231], v[248:251], v[196:199]
    v_perm_b32 v232, v133, v129, s72
    v_perm_b32 v236, v133, v129, s73
    v_perm_b32 v233, v141, v137, s72
    v_perm_b32 v237, v141, v137, s73
    v_perm_b32 v234, v149, v145, s72
    v_perm_b32 v238, v149, v145, s73
    v_perm_b32 v235, v157, v153, s72
    v_perm_b32 v239, v157, v153, s73
    s_nop 1
    v_mfma_f32_16x16x32_bf16 v[200:203], v[232:235], v[248:251], v[200:203]
    v_mfma_f32_16x16x32_bf16 v[204:207], v[236:239], v[248:251], v[204:207]
    s_waitcnt vmcnt(2)
    buffer_load_dwordx4 v[172:175], v6, s[8:11], s54 offen offset:768 nt
    v_perm_b32 v224, v134, v130, s72
    v_perm_b32 v228, v134, v130, s73
    v_perm_b32 v225, v142, v138, s72
    v_perm_b32 v229, v142, v138, s73
    v_perm_b32 v226, v150, v146, s72
    v_perm_b32 v230, v150, v146, s73
    v_perm_b32 v227, v158, v154, s72
    v_perm_b32 v231, v158, v154, s73
    s_nop 1
    v_mfma_f32_16x16x32_bf16 v[208:211], v[224:227], v[248:251], v[208:211]
    v_mfma_f32_16x16x32_bf16 v[212:215], v[228:231], v[248:251], v[212:215]
    v_perm_b32 v232, v135, v131, s72
    v_perm_b32 v236, v135, v131, s73
    v_perm_b32 v233, v143, v139, s72
    v_perm_b32 v237, v143, v139, s73
    v_perm_b32 v234, v151, v147, s72
    v_perm_b32 v238, v151, v147, s73
    v_perm_b32 v235, v159, v155, s72
    v_perm_b32 v239, v159, v155, s73
    s_nop 1
    v_mfma_f32_16x16x32_bf16 v[216:219], v[232:235], v[248:251], v[216:219]
    v_mfma_f32_16x16x32_bf16 v[220:223], v[236:239], v[248:251], v[220:223]
    s_waitcnt vmcnt(2)
    buffer_load_dwordx4 v[176:179], v6, s[8:11], s55 offen offset:0 nt
    s_waitcnt vmcnt(2)
    buffer_load_dwordx4 v[180:183], v6, s[8:11], s55 offen offset:256 nt
    s_waitcnt vmcnt(2)
    buffer_load_dwordx4 v[184:187], v6, s[8:11], s55 offen offset:512 nt
    s_waitcnt vmcnt(2)
    buffer_load_dwordx4 v[188:191], v6, s[8:11], s55 offen offset:768 nt
    v_lshrrev_b32 v115, 5, v1
    v_mul_u32_u24 v115, 17408, v115
    v_and_b32 v116, 31, v1
    v_lshl_add_u32 v115, v116, 4, v115
    s_mul_i32 s65, s3, 544
    v_add_u32 v115, s65, v115
    v_and_b32 v117, 7, v1
    v_lshlrev_b32 v118, 10, v117
    v_lshlrev_b32 v117, 5, v117
    v_lshrrev_b32 v119, 2, v116
    v_lshlrev_b32 v119, 12, v119
    v_and_b32 v116, 3, v1
    v_lshl_add_u32 v119, v116, 4, v119
    s_lshl_b32 s67, s44, 18
    s_lshl_b32 s65, s45, 6
    s_add_u32 s67, s67, s65
    s_lshl_b32 s65, s3, 15
    s_add_u32 s67, s67, s65
    s_add_u32 s67, s67, 1048576
    s_lshl_b32 s66, s44, 13
    s_lshl_b32 s65, s45, 4
    s_add_u32 s66, s66, s65
    s_add_u32 s66, s66, 262144
    s_lshl_b32 s94, 1, s3
    s_mov_b32 s95, 0
    v_mov_b32 v146, s47
    v_mov_b32 v147, s47
    v_and_b32 v11, 7, v1
    v_mul_u32_u24 v11, 544, v11
    v_bfe_u32 v109, v1, 3, 1
    v_lshl_add_u32 v11, v109, 4, v11
    v_lshl_add_u32 v11, v3, 7, v11
    s_mul_i32 s64, s3, 4352
    v_add_u32 v11, s64, v11
    v_mov_b32 v116, 1
    s_waitcnt vmcnt(0)
    v_mov_b32 v56, 0
    v_and_b32 v10, 7, v1
    v_lshlrev_b32 v10, 5, v10
    ds_read_b32 v59, v56 offset:10976
    ds_read_b128 v[100:103], v10 offset:10368
    ds_read_b128 v[104:107], v10 offset:10384
    v_perm_b32 v224, v164, v160, s72
    v_perm_b32 v228, v164, v160, s73
    v_perm_b32 v225, v172, v168, s72
    v_perm_b32 v229, v172, v168, s73
    v_perm_b32 v226, v180, v176, s72
    v_perm_b32 v230, v180, v176, s73
    v_perm_b32 v227, v188, v184, s72
    v_perm_b32 v231, v188, v184, s73
    s_nop 1
    v_mfma_f32_16x16x32_bf16 v[192:195], v[224:227], v[252:255], v[192:195]
    v_mfma_f32_16x16x32_bf16 v[196:199], v[228:231], v[252:255], v[196:199]
    v_perm_b32 v232, v165, v161, s72
    v_perm_b32 v236, v165, v161, s73
    v_perm_b32 v233, v173, v169, s72
    v_perm_b32 v237, v173, v169, s73
    v_perm_b32 v234, v181, v177, s72
    v_perm_b32 v238, v181, v177, s73
    v_perm_b32 v235, v189, v185, s72
    v_perm_b32 v239, v189, v185, s73
    s_nop 1
    v_mfma_f32_16x16x32_bf16 v[200:203], v[232:235], v[252:255], v[200:203]
    v_mfma_f32_16x16x32_bf16 v[204:207], v[236:239], v[252:255], v[204:207]
    v_perm_b32 v224, v166, v162, s72
    v_perm_b32 v228, v166, v162, s73
    v_perm_b32 v225, v174, v170, s72
    v_perm_b32 v229, v174, v170, s73
    v_perm_b32 v226, v182, v178, s72
    v_perm_b32 v230, v182, v178, s73
    v_perm_b32 v227, v190, v186, s72
    v_perm_b32 v231, v190, v186, s73
    s_nop 1
    v_mfma_f32_16x16x32_bf16 v[208:211], v[224:227], v[252:255], v[208:211]
    v_mfma_f32_16x16x32_bf16 v[212:215], v[228:231], v[252:255], v[212:215]
    v_perm_b32 v232, v167, v163, s72
    v_perm_b32 v236, v167, v163, s73
    v_perm_b32 v233, v175, v171, s72
    v_perm_b32 v237, v175, v171, s73
    v_perm_b32 v234, v183, v179, s72
    v_perm_b32 v238, v183, v179, s73
    v_perm_b32 v235, v191, v187, s72
    v_perm_b32 v239, v191, v187, s73
    s_nop 1
    v_mfma_f32_16x16x32_bf16 v[216:219], v[232:235], v[252:255], v[216:219]
    v_mfma_f32_16x16x32_bf16 v[220:223], v[236:239], v[252:255], v[220:223]
    s_mov_b32 s76, 0
L_MS70:
    s_waitcnt lgkmcnt(0)
    v_readfirstlane_b32 s64, v59
    s_cmp_ge_u32 s64, 8
    s_cbranch_scc1 L_MD71
    s_add_u32 s76, s76, 1
    s_cmp_lt_u32 s76, 4000000
    s_cbranch_scc0 L_MD71
    ds_read_b32 v59, v56 offset:10976
    ds_read_b128 v[100:103], v10 offset:10368
    ds_read_b128 v[104:107], v10 offset:10384
    s_branch L_MS70
L_MD71:
    v_max3_f32 v10, v100, v101, v102
    v_max3_f32 v10, v10, v103, v104
    v_max3_f32 v10, v10, v105, v106
    v_max_f32 v10, v10, v107
    v_sub_f32 v108, v8, v10
    v_exp_f32 v108, v108
    v_mov_b32 v144, v10
    v_mul_f32 v9, v9, v108
    ds_write_b32 v60, v9 offset:10624
    v_add_f32_dpp v224, v192, v192 row_ror:8 row_mask:0xf bank_mask:0x3
    v_add_f32_dpp v224, v208, v208 row_ror:8 row_mask:0xf bank_mask:0xc
    v_add_f32_dpp v225, v196, v196 row_ror:8 row_mask:0xf bank_mask:0x3
    v_add_f32_dpp v225, v212, v212 row_ror:8 row_mask:0xf bank_mask:0xc
    v_add_f32_dpp v226, v200, v200 row_ror:8 row_mask:0xf bank_mask:0x3
    v_add_f32_dpp v226, v216, v216 row_ror:8 row_mask:0xf bank_mask:0xc
    v_add_f32_dpp v227, v204, v204 row_ror:8 row_mask:0xf bank_mask:0x3
    v_add_f32_dpp v227, v220, v220 row_ror:8 row_mask:0xf bank_mask:0xc
    v_pk_mul_f32 v[224:225], v[224:225], v[108:109] op_sel_hi:[1,0]
    v_pk_mul_f32 v[226:227], v[226:227], v[108:109] op_sel_hi:[1,0]
    ds_write_b128 v11, v[224:227] offset:13312
    v_add_f32_dpp v228, v193, v193 row_ror:8 row_mask:0xf bank_mask:0x3
    v_add_f32_dpp v228, v209, v209 row_ror:8 row_mask:0xf bank_mask:0xc
    v_add_f32_dpp v229, v197, v197 row_ror:8 row_mask:0xf bank_mask:0x3
    v_add_f32_dpp v229, v213, v213 row_ror:8 row_mask:0xf bank_mask:0xc
    v_add_f32_dpp v230, v201, v201 row_ror:8 row_mask:0xf bank_mask:0x3
    v_add_f32_dpp v230, v217, v217 row_ror:8 row_mask:0xf bank_mask:0xc
    v_add_f32_dpp v231, v205, v205 row_ror:8 row_mask:0xf bank_mask:0x3
    v_add_f32_dpp v231, v221, v221 row_ror:8 row_mask:0xf bank_mask:0xc
    v_pk_mul_f32 v[228:229], v[228:229], v[108:109] op_sel_hi:[1,0]
    v_pk_mul_f32 v[230:231], v[230:231], v[108:109] op_sel_hi:[1,0]
    ds_write_b128 v11, v[228:231] offset:13344
    v_add_f32_dpp v232, v194, v194 row_ror:8 row_mask:0xf bank_mask:0x3
    v_add_f32_dpp v232, v210, v210 row_ror:8 row_mask:0xf bank_mask:0xc
    v_add_f32_dpp v233, v198, v198 row_ror:8 row_mask:0xf bank_mask:0x3
    v_add_f32_dpp v233, v214, v214 row_ror:8 row_mask:0xf bank_mask:0xc
    v_add_f32_dpp v234, v202, v202 row_ror:8 row_mask:0xf bank_mask:0x3
    v_add_f32_dpp v234, v218, v218 row_ror:8 row_mask:0xf bank_mask:0xc
    v_add_f32_dpp v235, v206, v206 row_ror:8 row_mask:0xf bank_mask:0x3
    v_add_f32_dpp v235, v222, v222 row_ror:8 row_mask:0xf bank_mask:0xc
    v_pk_mul_f32 v[232:233], v[232:233], v[108:109] op_sel_hi:[1,0]
    v_pk_mul_f32 v[234:235], v[234:235], v[108:109] op_sel_hi:[1,0]
    ds_write_b128 v11, v[232:235] offset:13376
    v_add_f32_dpp v236, v195, v195 row_ror:8 row_mask:0xf bank_mask:0x3
    v_add_f32_dpp v236, v211, v211 row_ror:8 row_mask:0xf bank_mask:0xc
    v_add_f32_dpp v237, v199, v199 row_ror:8 row_mask:0xf bank_mask:0x3
    v_add_f32_dpp v237, v215, v215 row_ror:8 row_mask:0xf bank_mask:0xc
    v_add_f32_dpp v238, v203, v203 row_ror:8 row_mask:0xf bank_mask:0x3
    v_add_f32_dpp v238, v219, v219 row_ror:8 row_mask:0xf bank_mask:0xc
    v_add_f32_dpp v239, v207, v207 row_ror:8 row_mask:0xf bank_mask:0x3
    v_add_f32_dpp v239, v223, v223 row_ror:8 row_mask:0xf bank_mask:0xc
    v_pk_mul_f32 v[236:237], v[236:237], v[108:109] op_sel_hi:[1,0]
    v_pk_mul_f32 v[238:239], v[238:239], v[108:109] op_sel_hi:[1,0]
    ds_write_b128 v11, v[236:239] offset:13408
    s_mov_b64 exec, 1
    ds_add_rtn_u32 v59, v56, v116 offset:10980
    s_mov_b64 exec, -1
    s_waitcnt lgkmcnt(0)
    s_barrier
    ds_read_b128 v[128:131], v115 offset:13312
    ds_read_b128 v[132:135], v115 offset:17664
    ds_read_b128 v[136:139], v115 offset:22016
    ds_read_b128 v[140:143], v115 offset:26368
    ds_read_b128 v[100:103], v117 offset:10624
    ds_read_b128 v[104:107], v117 offset:10640
    v_readfirstlane_b32 s64, v59
    s_cmp_eq_u32 s64, 0
    s_cselect_b32 s80, 1, 0
    s_waitcnt lgkmcnt(4)
    v_pk_add_f32 v[128:129], v[128:129], v[132:133]
    v_pk_add_f32 v[130:131], v[130:131], v[134:135]
    s_waitcnt lgkmcnt(2)
    v_pk_add_f32 v[136:137], v[136:137], v[140:141]
    v_pk_add_f32 v[138:139], v[138:139], v[142:143]
    v_pk_add_f32 v[128:129], v[128:129], v[136:137]
    v_pk_add_f32 v[130:131], v[130:131], v[138:139]
    v_mov_b32 v132, v128
    v_mov_b32 v133, v129
    v_mov_b32 v134, v130
    v_mov_b32 v135, v131
    s_nop 1
    v_permlane32_swap_b32 v128, v132
    v_permlane32_swap_b32 v129, v133
    v_permlane32_swap_b32 v130, v134
    v_permlane32_swap_b32 v131, v135
    s_waitcnt lgkmcnt(0)
    v_pk_add_f32 v[128:129], v[128:129], v[132:133]
    v_pk_add_f32 v[130:131], v[130:131], v[134:135]
    v_pk_add_f32 v[100:101], v[100:101], v[102:103]
    v_pk_add_f32 v[104:105], v[104:105], v[106:107]
    v_bfi_b32 v128, s77, v128, v12
    v_bfi_b32 v129, s77, v129, v13
    v_bfi_b32 v130, s77, v130, v14
    v_bfi_b32 v131, s77, v131, v15
    v_pk_add_f32 v[100:101], v[100:101], v[104:105]
    v_add_f32 v145, v100, v101
    s_mov_b64 exec, 0xffffffff
    buffer_store_dwordx4 v[128:131], v119, s[12:15], s67 offen sc1
    s_mov_b64 exec, s[94:95]
    buffer_store_dwordx4 v[144:147], v118, s[12:15], s66 offen sc1
    s_mov_b64 exec, -1
    s_barrier
    buffer_load_dwordx4 v[32:35], v2, s[84:87], s60 offen offset:0 nt
    buffer_load_dwordx4 v[36:39], v2, s[84:87], s60 offen offset:2048 nt
    buffer_load_dwordx4 v[40:43], v2, s[84:87], s61 offen offset:0 nt
    buffer_load_dwordx4 v[44:47], v2, s[84:87], s61 offen offset:2048 nt
    v_lshlrev_b32 v110, 4, v1
    v_lshrrev_b32 v111, 2, v1
    v_lshlrev_b32 v111, 4, v111
    s_lshl_b32 s66, s2, 12
    s_add_u32 s66, s66, 1048576
    s_lshr_b32 s67, s2, 3
    s_lshl_b32 s67, s67, 10
    s_add_u32 s67, s67, 262144
    s_cmp_eq_u32 s80, 0
    s_cbranch_scc1 L_NP72
    buffer_load_dwordx4 v[160:163], v110, s[12:15], s66 offen offset:0 sc1
    buffer_load_dwordx3 v[176:178], v111, s[12:15], s67 offen offset:0 sc1
    buffer_load_dwordx4 v[164:167], v110, s[12:15], s66 offen offset:1024 sc1
    buffer_load_dwordx3 v[180:182], v111, s[12:15], s67 offen offset:256 sc1
    buffer_load_dwordx4 v[168:171], v110, s[12:15], s66 offen offset:2048 sc1
    buffer_load_dwordx3 v[184:186], v111, s[12:15], s67 offen offset:512 sc1
    buffer_load_dwordx4 v[172:175], v110, s[12:15], s66 offen offset:3072 sc1
    buffer_load_dwordx3 v[188:190], v111, s[12:15], s67 offen offset:768 sc1
L_NP72:
    v_and_b32 v112, 31, v1
    v_lshlrev_b32 v112, 1, v112
    s_lshl_b32 s68, s98, 6
    buffer_load_ushort v113, v112, s[16:19], s68 offen
    s_cmp_eq_u32 s80, 0
    s_cbranch_scc1 L_NP73
    s_mov_b64 s[74:75], -1
    s_mov_b32 s76, 0
L_PL74:
    s_waitcnt vmcnt(0)
    v_xor_b32 v128, v12, v160
    v_xor_b32 v129, v13, v161
    v_xor_b32 v130, v14, v162
    v_xor_b32 v131, v15, v163
    v_xor_b32 v132, v12, v164
    v_xor_b32 v133, v13, v165
    v_xor_b32 v134, v14, v166
    v_xor_b32 v135, v15, v167
    v_xor_b32 v136, v12, v168
    v_xor_b32 v137, v13, v169
    v_xor_b32 v138, v14, v170
    v_xor_b32 v139, v15, v171
    v_xor_b32 v140, v12, v172
    v_xor_b32 v141, v13, v173
    v_xor_b32 v142, v14, v174
    v_xor_b32 v143, v15, v175
    v_or3_b32 v56, v128, v129, v130
    v_or_b32 v56, v56, v131
    v_or3_b32 v56, v56, v132, v133
    v_or3_b32 v56, v56, v134, v135
    v_or3_b32 v56, v56, v136, v137
    v_or3_b32 v56, v56, v138, v139
    v_or3_b32 v56, v56, v140, v141
    v_or3_b32 v56, v56, v142, v143
    v_and_b32 v56, 0xff, v56
    v_pk_mov_b32 v[144:145], v[176:177], v[176:177] op_sel:[0,1]
    v_xor_b32 v147, s47, v178
    v_pk_mov_b32 v[148:149], v[180:181], v[180:181] op_sel:[0,1]
    v_xor_b32 v151, s47, v182
    v_pk_mov_b32 v[152:153], v[184:185], v[184:185] op_sel:[0,1]
    v_xor_b32 v155, s47, v186
    v_pk_mov_b32 v[156:157], v[188:189], v[188:189] op_sel:[0,1]
    v_xor_b32 v159, s47, v190
    v_or3_b32 v56, v56, v147, v151
    v_or3_b32 v56, v56, v155, v159
    v_cmp_ne_u32 vcc, 0, v56
    s_mov_b64 exec, -1
    s_cbranch_vccz L_PD75
    s_add_u32 s76, s76, 1
    s_cmp_lt_u32 s76, 200000
    s_cbranch_scc0 L_PD75
    s_sleep 1
    s_mov_b64 exec, vcc
    buffer_load_dwordx4 v[160:163], v110, s[12:15], s66 offen offset:0 sc1
    buffer_load_dwordx3 v[176:178], v111, s[12:15], s67 offen offset:0 sc1
    buffer_load_dwordx4 v[164:167], v110, s[12:15], s66 offen offset:1024 sc1
    buffer_load_dwordx3 v[180:182], v111, s[12:15], s67 offen offset:256 sc1
    buffer_load_dwordx4 v[168:171], v110, s[12:15], s66 offen offset:2048 sc1
    buffer_load_dwordx3 v[184:186], v111, s[12:15], s67 offen offset:512 sc1
    buffer_load_dwordx4 v[172:175], v110, s[12:15], s66 offen offset:3072 sc1
    buffer_load_dwordx3 v[188:190], v111, s[12:15], s67 offen offset:768 sc1
    s_branch L_PL74
L_PD75:
    v_max3_f32 v100, v144, v148, v152
    v_max_f32 v100, v100, v156
    s_nop 1
    v_max_f32_dpp v100, v100, v100 row_ror:4 row_mask:0xf bank_mask:0xf
    s_nop 1
    v_max_f32_dpp v100, v100, v100 row_ror:8 row_mask:0xf bank_mask:0xf
    v_mov_b32 v56, v100
    s_nop 1
    v_permlane16_swap_b32 v100, v56
    v_max_f32 v100, v100, v56
    v_mov_b32 v56, v100
    s_nop 1
    v_permlane32_swap_b32 v100, v56
    v_max_f32 v100, v100, v56
    v_sub_f32 v144, v144, v100
    v_sub_f32 v148, v148, v100
    v_sub_f32 v152, v152, v100
    v_sub_f32 v156, v156, v100
    v_exp_f32 v144, v144
    v_exp_f32 v148, v148
    v_exp_f32 v152, v152
    v_exp_f32 v156, v156
    s_nop 0
    v_mul_f32 v104, v144, v145
    v_mul_f32 v100, v144, v128
    v_mul_f32 v101, v144, v129
    v_mul_f32 v102, v144, v130
    v_mul_f32 v103, v144, v131
    v_fmac_f32 v104, v148, v149
    v_fmac_f32 v100, v148, v132
    v_fmac_f32 v101, v148, v133
    v_fmac_f32 v102, v148, v134
    v_fmac_f32 v103, v148, v135
    v_fmac_f32 v104, v152, v153
    v_fmac_f32 v100, v152, v136
    v_fmac_f32 v101, v152, v137
    v_fmac_f32 v102, v152, v138
    v_fmac_f32 v103, v152, v139
    v_fmac_f32 v104, v156, v157
    v_fmac_f32 v100, v156, v140
    v_fmac_f32 v101, v156, v141
    v_fmac_f32 v102, v156, v142
    v_fmac_f32 v103, v156, v143
    s_nop 1
    v_add_f32_dpp v100, v100, v100 row_ror:4 row_mask:0xf bank_mask:0xf
    v_add_f32_dpp v101, v101, v101 row_ror:4 row_mask:0xf bank_mask:0xf
    v_add_f32_dpp v102, v102, v102 row_ror:4 row_mask:0xf bank_mask:0xf
    v_add_f32_dpp v103, v103, v103 row_ror:4 row_mask:0xf bank_mask:0xf
    v_add_f32_dpp v104, v104, v104 row_ror:4 row_mask:0xf bank_mask:0xf
    s_nop 1
    v_add_f32_dpp v100, v100, v100 row_ror:8 row_mask:0xf bank_mask:0xf
    v_add_f32_dpp v101, v101, v101 row_ror:8 row_mask:0xf bank_mask:0xf
    v_add_f32_dpp v102, v102, v102 row_ror:8 row_mask:0xf bank_mask:0xf
    v_add_f32_dpp v103, v103, v103 row_ror:8 row_mask:0xf bank_mask:0xf
    v_add_f32_dpp v104, v104, v104 row_ror:8 row_mask:0xf bank_mask:0xf
    v_mov_b32 v105, v100
    v_mov_b32 v106, v101
    v_mov_b32 v107, v102
    v_mov_b32 v108, v103
    v_mov_b32 v109, v104
    s_nop 1
    v_permlane16_swap_b32 v100, v105
    v_permlane16_swap_b32 v101, v106
    v_permlane16_swap_b32 v102, v107
    v_permlane16_swap_b32 v103, v108
    v_permlane16_swap_b32 v104, v109
    v_add_f32 v100, v100, v105
    v_add_f32 v101, v101, v106
    v_add_f32 v102, v102, v107
    v_add_f32 v103, v103, v108
    v_add_f32 v104, v104, v109
    v_mov_b32 v105, v100
    v_mov_b32 v106, v101
    v_mov_b32 v107, v102
    v_mov_b32 v108, v103
    v_mov_b32 v109, v104
    s_nop 1
    v_permlane32_swap_b32 v100, v105
    v_permlane32_swap_b32 v101, v106
    v_permlane32_swap_b32 v102, v107
    v_permlane32_swap_b32 v103, v108
    v_permlane32_swap_b32 v104, v109
    v_add_f32 v100, v100, v105
    v_add_f32 v101, v101, v106
    v_add_f32 v102, v102, v107
    v_add_f32 v103, v103, v108
    v_add_f32 v104, v104, v109
    v_rcp_f32 v104, v104
    v_lshlrev_b32 v56, 4, v1
    v_mov_b32 v106, 1
    v_mov_b32 v107, 1
    v_mul_f32 v100, v100, v104
    v_mul_f32 v101, v101, v104
    v_mul_f32 v102, v102, v104
    v_mul_f32 v103, v103, v104
    v_cvt_pk_bf16_f32 v104, v100, v101
    v_cvt_pk_bf16_f32 v105, v102, v103
    s_mov_b64 exec, 0xf
    ds_write_b128 v56, v[104:107] offset:10880
    s_mov_b64 exec, -1
L_NP73:
    v_lshlrev_b32 v56, 4, v3
    v_lshrrev_b32 v114, 2, v4
    v_mul_u32_u24 v114, 36864, v114
    v_and_b32 v59, 3, v4
    v_lshl_add_u32 v114, v59, 5, v114
    v_lshrrev_b32 v59, 5, v1
    v_lshl_add_u32 v114, v59, 4, v114
    s_mul_i32 s64, s3, 147456
    s_lshl_b32 s65, s2, 7
    s_add_u32 s64, s64, s65
    s_add_u32 s64, s64, 2097152
    s_mov_b32 s94, 0xffff
    s_mov_b32 s95, 0xffff
    s_mov_b32 s76, 0
L_OL76:
    ds_read_b128 v[104:107], v56 offset:10880
    s_waitcnt lgkmcnt(0)
    v_cmp_ne_u32 vcc, 1, v106
    s_cbranch_vccz L_OD77
    s_sleep 1
    s_add_u32 s76, s76, 1
    s_cmp_lt_u32 s76, 4000000
    s_cbranch_scc1 L_OL76
L_OD77:
    s_cmp_lg_u32 s80, 0
    s_cbranch_scc1 L_SW78
    s_waitcnt vmcnt(1)
L_SW78:
    v_mov_b32 v120, 0
    v_mov_b32 v121, 0
    v_mov_b32 v122, 0
    v_mov_b32 v123, 0
    v_mov_b32 v124, 0
    v_mov_b32 v125, 0
    v_mov_b32 v126, 0
    v_mov_b32 v127, 0
    v_and_b32 v56, 0xffff, v104
    v_lshlrev_b32 v59, 16, v104
    v_dot2c_f32_bf16 v120, v32, v56
    v_dot2c_f32_bf16 v121, v32, v59
    v_dot2c_f32_bf16 v122, v33, v56
    v_dot2c_f32_bf16 v123, v33, v59
    v_dot2c_f32_bf16 v124, v34, v56
    v_dot2c_f32_bf16 v125, v34, v59
    v_dot2c_f32_bf16 v126, v35, v56
    v_dot2c_f32_bf16 v127, v35, v59
    v_lshrrev_b32 v56, 16, v104
    v_and_b32 v59, 0xffff0000, v104
    v_dot2c_f32_bf16 v120, v36, v56
    v_dot2c_f32_bf16 v121, v36, v59
    v_dot2c_f32_bf16 v122, v37, v56
    v_dot2c_f32_bf16 v123, v37, v59
    v_dot2c_f32_bf16 v124, v38, v56
    v_dot2c_f32_bf16 v125, v38, v59
    v_dot2c_f32_bf16 v126, v39, v56
    v_dot2c_f32_bf16 v127, v39, v59
    v_and_b32 v56, 0xffff, v105
    v_lshlrev_b32 v59, 16, v105
    v_dot2c_f32_bf16 v120, v40, v56
    v_dot2c_f32_bf16 v121, v40, v59
    v_dot2c_f32_bf16 v122, v41, v56
    v_dot2c_f32_bf16 v123, v41, v59
    v_dot2c_f32_bf16 v124, v42, v56
    v_dot2c_f32_bf16 v125, v42, v59
    v_dot2c_f32_bf16 v126, v43, v56
    v_dot2c_f32_bf16 v127, v43, v59
    v_lshrrev_b32 v56, 16, v105
    v_and_b32 v59, 0xffff0000, v105
    v_dot2c_f32_bf16 v120, v44, v56
    v_dot2c_f32_bf16 v121, v44, v59
    v_dot2c_f32_bf16 v122, v45, v56
    v_dot2c_f32_bf16 v123, v45, v59
    v_dot2c_f32_bf16 v124, v46, v56
    v_dot2c_f32_bf16 v125, v46, v59
    v_dot2c_f32_bf16 v126, v47, v56
    v_dot2c_f32_bf16 v127, v47, v59
    s_nop 1
    v_permlane32_swap_b32 v120, v124
    v_permlane32_swap_b32 v121, v125
    v_permlane32_swap_b32 v122, v126
    v_permlane32_swap_b32 v123, v127
    v_add_f32 v120, v120, v124
    v_add_f32 v121, v121, v125
    v_add_f32 v122, v122, v126
    v_add_f32 v123, v123, v127
    v_mov_b32 v124, v120
    v_mov_b32 v125, v121
    v_mov_b32 v126, v122
    v_mov_b32 v127, v123
    s_nop 1
    v_permlane16_swap_b32 v120, v124
    v_permlane16_swap_b32 v121, v125
    v_permlane16_swap_b32 v122, v126
    v_permlane16_swap_b32 v123, v127
    v_add_f32 v120, v120, v124
    v_add_f32 v121, v121, v125
    v_add_f32 v122, v122, v126
    v_add_f32 v123, v123, v127
    v_bfi_b32 v120, s77, v120, v12
    v_bfi_b32 v121, s77, v121, v13
    v_bfi_b32 v122, s77, v122, v14
    v_bfi_b32 v123, s77, v123, v15
    s_mov_b64 exec, s[94:95]
    buffer_store_dwordx4 v[120:123], v114, s[12:15], s64 offen sc1
    s_mov_b64 exec, -1
    s_mul_i32 s66, s98, 36864
    s_add_u32 s66, s66, 2097152
    s_lshl_b32 s65, s3, 12
    s_add_u32 s66, s66, s65
    s_mul_i32 s65, s3, 3584
    s_sub_u32 s65, 32768, s65
    s_cmp_lt_u32 s3, 7
    s_cselect_b32 s78, -1, 0
    s_mov_b32 s79, 0
    v_add_u32 v115, s65, v110
    v_cndmask_b32 v115, v110, v115, s[78:79]
    v_and_b32 v116, 1, v3
    v_lshlrev_b32 v116, 1, v116
    v_lshrrev_b32 v59, 1, v3
    v_or_b32 v116, v116, v59
    v_and_b32 v59, 7, v1
    v_lshl_add_u32 v116, v59, 2, v116
    v_lshlrev_b32 v116, 3, v116
    s_lshl_b32 s64, s3, 8
    v_add_u32 v116, s64, v116
    v_lshlrev_b32 v117, 2, v112
    v_mov_b32 v118, 0
    v_mov_b32 v119, 1
    s_mov_b64 s[74:75], -1
    s_mov_b32 s76, 0
    buffer_load_dwordx4 v[160:163], v110, s[12:15], s66 offen offset:0 sc1
    buffer_load_dwordx4 v[164:167], v110, s[12:15], s66 offen offset:1024 sc1
    buffer_load_dwordx4 v[168:171], v110, s[12:15], s66 offen offset:2048 sc1
    buffer_load_dwordx4 v[172:175], v110, s[12:15], s66 offen offset:3072 sc1
    buffer_load_dwordx4 v[176:179], v115, s[12:15], s66 offen sc1
L_PL81:
    s_waitcnt vmcnt(0)
    v_xor_b32 v128, v12, v160
    v_xor_b32 v129, v13, v161
    v_xor_b32 v130, v14, v162
    v_xor_b32 v131, v15, v163
    v_xor_b32 v132, v12, v164
    v_xor_b32 v133, v13, v165
    v_xor_b32 v134, v14, v166
    v_xor_b32 v135, v15, v167
    v_xor_b32 v136, v12, v168
    v_xor_b32 v137, v13, v169
    v_xor_b32 v138, v14, v170
    v_xor_b32 v139, v15, v171
    v_xor_b32 v140, v12, v172
    v_xor_b32 v141, v13, v173
    v_xor_b32 v142, v14, v174
    v_xor_b32 v143, v15, v175
    v_xor_b32 v144, v12, v176
    v_xor_b32 v145, v13, v177
    v_xor_b32 v146, v14, v178
    v_xor_b32 v147, v15, v179
    v_or3_b32 v56, v128, v129, v130
    v_or_b32 v56, v56, v131
    v_or3_b32 v56, v56, v132, v133
    v_or3_b32 v56, v56, v134, v135
    v_or3_b32 v56, v56, v136, v137
    v_or3_b32 v56, v56, v138, v139
    v_or3_b32 v56, v56, v140, v141
    v_or3_b32 v56, v56, v142, v143
    v_or3_b32 v56, v56, v144, v145
    v_or3_b32 v56, v56, v146, v147
    v_and_b32 v56, 0xff, v56
    v_cmp_ne_u32 vcc, 0, v56
    s_mov_b64 exec, -1
    s_cbranch_vccz L_PD82
    s_add_u32 s76, s76, 1
    s_cmp_lt_u32 s76, 200000
    s_cbranch_scc0 L_PD82
    s_sleep 1
    s_mov_b64 exec, vcc
    buffer_load_dwordx4 v[160:163], v110, s[12:15], s66 offen offset:0 sc1
    buffer_load_dwordx4 v[164:167], v110, s[12:15], s66 offen offset:1024 sc1
    buffer_load_dwordx4 v[168:171], v110, s[12:15], s66 offen offset:2048 sc1
    buffer_load_dwordx4 v[172:175], v110, s[12:15], s66 offen offset:3072 sc1
    buffer_load_dwordx4 v[176:179], v115, s[12:15], s66 offen sc1
    s_branch L_PL81
L_PD82:
    v_cndmask_b32 v144, 0, v144, s[78:79]
    v_cndmask_b32 v145, 0, v145, s[78:79]
    v_cndmask_b32 v146, 0, v146, s[78:79]
    v_cndmask_b32 v147, 0, v147, s[78:79]
    v_pk_add_f32 v[128:129], v[128:129], v[132:133]
    v_pk_add_f32 v[130:131], v[130:131], v[134:135]
    v_pk_add_f32 v[136:137], v[136:137], v[140:141]
    v_pk_add_f32 v[138:139], v[138:139], v[142:143]
    v_pk_add_f32 v[140:141], v[128:129], v[136:137]
    v_pk_add_f32 v[142:143], v[130:131], v[138:139]
    s_nop 1
    v_permlane32_swap_b32 v140, v141
    v_permlane32_swap_b32 v142, v143
    v_permlane32_swap_b32 v144, v145
    v_permlane32_swap_b32 v146, v147
    v_add_f32 v140, v140, v141
    v_add_f32 v142, v142, v143
    v_add_f32 v144, v144, v145
    v_add_f32 v146, v146, v147
    s_nop 1
    v_permlane16_swap_b32 v140, v142
    v_permlane16_swap_b32 v144, v146
    v_add_f32 v140, v140, v142
    v_add_f32 v144, v144, v146
    s_nop 1
    v_add_f32_dpp v140, v140, v140 row_ror:8 row_mask:0xf bank_mask:0xf
    v_add_f32_dpp v144, v144, v144 row_ror:8 row_mask:0xf bank_mask:0xf
    v_mov_b32 v141, v144
    v_mov_b32 v59, 0
    s_mov_b32 s76, 0
    ds_write_b64 v116, v[140:141] offset:11264
    s_mov_b64 exec, 1
    ds_add_rtn_u32 v119, v118, v119 offset:10988
    s_mov_b64 exec, -1
    ds_read_b64 v[64:65], v117 offset:11264
    ds_read_b64 v[66:67], v117 offset:11520
    ds_read_b64 v[68:69], v117 offset:11776
    ds_read_b64 v[70:71], v117 offset:12032
    ds_read_b64 v[72:73], v117 offset:12288
    ds_read_b64 v[74:75], v117 offset:12544
    ds_read_b64 v[76:77], v117 offset:12800
    ds_read_b64 v[78:79], v117 offset:13056
    s_waitcnt lgkmcnt(8)
    v_readfirstlane_b32 s64, v119
    s_cmp_lg_u32 s64, 7
    s_cbranch_scc1 L_FIN_END
L_F79:
    ds_read_b128 v[100:103], v59 offset:10944
    s_waitcnt lgkmcnt(0)
    v_cmp_ne_u32 vcc, 1, v103
    s_cbranch_vccz L_F80
    s_add_u32 s76, s76, 1
    s_cmp_lt_u32 s76, 4000000
    s_cbranch_scc1 L_F79
L_F80:
    v_pk_add_f32 v[64:65], v[64:65], v[66:67]
    v_pk_add_f32 v[68:69], v[68:69], v[70:71]
    v_pk_add_f32 v[72:73], v[72:73], v[74:75]
    v_pk_add_f32 v[76:77], v[76:77], v[78:79]
    v_pk_add_f32 v[64:65], v[64:65], v[68:69]
    v_pk_add_f32 v[72:73], v[72:73], v[76:77]
    v_pk_add_f32 v[64:65], v[64:65], v[72:73]
    v_lshlrev_b32 v113, 16, v113
    v_cvt_pk_bf16_f32 v80, v64, v65
    v_and_b32 v81, 0xffff0000, v80
    v_lshlrev_b32 v80, 16, v80
    v_mul_f32 v81, v102, v81
    v_mul_f32 v80, v100, v80
    v_cvt_pk_bf16_f32 v80, v80, v81
    v_and_b32 v81, 0xffff0000, v80
    v_lshlrev_b32 v80, 16, v80
    v_add_f32 v81, v81, v113
    v_cvt_pk_bf16_f32 v81, v81, v81
    v_lshlrev_b32 v81, 16, v81
    v_mul_f32 v81, v101, v81
    v_cvt_pk_bf16_f32 v81, v81, v81
    v_lshlrev_b32 v81, 16, v81
    v_add_f32 v64, v80, v81
    v_cvt_pk_bf16_f32 v64, v64, v64
    s_mov_b64 exec, 0xffffffff
    buffer_store_short v64, v112, s[32:35], s68 offen
    s_mov_b64 exec, -1
L_FIN_END:
L_END:
    s_endpgm
.section .rodata,"a"
.p2align 6
.amdhsa_kernel gated_mix__gqa_block_cached__moe_arch_mod__decode_kernel
  .amdhsa_next_free_vgpr 256
  .amdhsa_next_free_sgpr 102
  .amdhsa_accum_offset 256
  .amdhsa_group_segment_fixed_size 0
  .amdhsa_kernarg_size 112
  .amdhsa_user_sgpr_count 2
  .amdhsa_user_sgpr_kernarg_segment_ptr 1
  .amdhsa_system_sgpr_workgroup_id_x 1
.end_amdhsa_kernel
```
